```python
import torch

def _softmax(x, axis=-1):
    return torch.softmax(x, dim=axis)
def _gelu(x):
    return torch.nn.functional.gelu(x, approximate="tanh")
def _silu(x):
    return torch.nn.functional.silu(x)
def _sigmoid(x):
    return torch.sigmoid(x)
def _layernorm(x, axis=-1, eps=1e-5):
    m = x.mean(dim=axis, keepdim=True)
    v = x.var(dim=axis, keepdim=True, unbiased=False)
    return (x - m) / torch.sqrt(v + eps)
def _scatter_add(tgt, idx, src, axis=0):
    return tgt.clone().index_add_(axis, idx, src)
def _segment_sum(src, seg, n):
    out = torch.zeros((n,) + src.shape[1:], dtype=src.dtype)
    return out.index_add_(0, seg, src)
def _pad(x, pw):
    flat = tuple(v for pair in reversed(pw) for v in pair)
    return torch.nn.functional.pad(x, flat)

kernel_name = 'sequential_preLN__gqa_block_cached__dense_activation_relu__decode'

def setup_inputs():

    _w = (lambda a: (lambda t: t.to(torch.bfloat16) if t.is_floating_point() else t)(torch.as_tensor(a)))
    def _A_setup():
        B, Sq, D = 2, 1, 640
        Hq, Hkv, Sk, Dh = 32, 32, 4096, 128
        assert Hq % Hkv == 0, (Hq, Hkv)
        return {
            "x": _w((lambda *s: torch.randn(*s, dtype=torch.bfloat16) * 0.05)(B, Sq, D)),
            "k_cache": _w((lambda *s: torch.randn(*s, dtype=torch.bfloat16) * 3.2)(B, Hkv, Sk, Dh)),
            "v_cache": _w((lambda *s: torch.randn(*s, dtype=torch.bfloat16) * 0.4)(B, Hkv, Sk, Dh)),
            "wq": _w((lambda *s: torch.randn(*s, dtype=torch.bfloat16) * 3.2)(D, Hq * Dh) * (D ** -0.5)),
            "wo": _w((lambda *s: torch.randn(*s, dtype=torch.bfloat16) * 0.4)(Hq * Dh, D) * ((Hq * Dh) ** -0.5)),
        }
    _A_in = _A_setup()

    def _B_setup():
        B, S, D, Dff = 2, 1, 640, 1728
        return {
            "x": _w((lambda *s: torch.randn(*s, dtype=torch.bfloat16) * 0.05)(B, S, D)),
            "w1": _w((lambda *s: torch.randn(*s, dtype=torch.bfloat16) * 0.05)(D, Dff)),
            "w2": _w((lambda *s: torch.randn(*s, dtype=torch.bfloat16) * 0.05)(Dff, D)),
        }
    _B_in = _B_setup()

    return {
        "A_x": _A_in["x"],
        "A_k_cache": _A_in["k_cache"],
        "A_v_cache": _A_in["v_cache"],
        "A_wq": _A_in["wq"],
        "A_wo": _A_in["wo"],
        "B_x": _B_in["x"],
        "B_w1": _B_in["w1"],
        "B_w2": _B_in["w2"],
    }

def reference(A_x, A_k_cache, A_v_cache, A_wq, A_wo, B_x, B_w1, B_w2):
    def _A_ref(x, k_cache, v_cache, wq, wo):
        B, Sq, D = x.shape
        Hq, Dh = 32, 128
        Hkv = k_cache.shape[1]
        rep = Hq // Hkv
        q = (lambda x, *d: x.permute(*d))((x @ wq).reshape(B, Sq, Hq, Dh), 0, 2, 1, 3)
        k = (lambda x, n, axis: torch.repeat_interleave(x, n, dim=axis))(k_cache, rep, axis=1)
        v = (lambda x, n, axis: torch.repeat_interleave(x, n, dim=axis))(v_cache, rep, axis=1)
        scores = torch.einsum("bhqd,bhkd->bhqk", q, k) * (Dh ** -0.5)
        p = _softmax(scores, axis=-1)
        o = torch.einsum("bhqk,bhkd->bhqd", p, v)
        return (lambda x, *d: x.permute(*d))(o, 0, 2, 1, 3).reshape(B, Sq, Hq * Dh) @ wo

    def _B_ref(x, w1, w2):
        h = torch.einsum("bsd,df->bsf", x, w1)
        zero = torch.zeros_like(h)
        h = torch.maximum(h, zero)
        return torch.einsum("bsf,fd->bsd", h, w2)

    x = A_x
    h = x + _A_ref(_layernorm(x, axis=-1), A_k_cache, A_v_cache, A_wq, A_wo)
    h2 = h + _B_ref(_layernorm(h, axis=-1), B_w1, B_w2)
    return h2
```

```asm
; @launch grid=(256,1,1) block=(512,1,1) lds=32768
.amdgcn_target "amdgcn-amd-amdhsa--gfx950"
.text
.globl sequential_preLN__gqa_block_cached__dense_activation_relu__decode_kernel
.p2align 8
.type sequential_preLN__gqa_block_cached__dense_activation_relu__decode_kernel,@function
sequential_preLN__gqa_block_cached__dense_activation_relu__decode_kernel:
    s_cmp_ge_u32 s2, 256
    s_cbranch_scc1 END
    s_load_dwordx16 s[44:59], s[0:1], 0
    s_load_dwordx4 s[60:63], s[0:1], 64
    s_load_dwordx2 s[64:65], s[0:1], 80
    v_lshrrev_b32 v3, 6, v0
    v_and_b32 v0, 63, v0
    v_readfirstlane_b32 s3, v3
    s_and_b32 s33, s2, 7
    s_lshr_b32 s40, s2, 3
    s_and_b32 s40, s40, 3
    s_mul_i32 s41, s40, 2
    s_add_u32 s33, s33, s41
    s_and_b32 s33, s33, 7
    s_lshl_b32 s40, s40, 3
    s_add_u32 s33, s33, s40
    s_lshr_b32 s40, s2, 5
    s_and_b32 s34, s40, 1
    s_lshr_b32 s35, s40, 1
    s_mov_b32 s37, 0x05040100
    s_mov_b32 s38, 0x07060302
    s_mov_b32 s39, 0xffff0000
    s_mov_b32 s69, 0x3fb8aa3b
    s_mov_b32 s70, 0x3db504f3
    s_mov_b32 s71, 0x3acccccd
    v_lshlrev_b32 v1, 4, v0
    s_lshl_b32 s40, s34, 5
    s_add_u32 s40, s40, s33
    s_lshl_b32 s40, s40, 20
    s_lshl_b32 s41, s35, 18
    s_add_u32 s40, s40, s41
    s_lshl_b32 s41, s3, 15
    s_add_u32 s40, s40, s41
    s_mul_i32 s41, s34, 1280
    v_lshlrev_b32 v3, 2, v0
    v_add_u32 v3, s41, v3
    v_lshrrev_b32 v254, 4, v0
    v_and_b32 v255, 15, v0
    s_mul_i32 s41, s3, 80
    v_add_u32 v2, s41, v254
    v_lshlrev_b32 v2, 13, v2
    s_lshl_b32 s41, s33, 8
    v_lshl_add_u32 v2, v255, 4, v2
    v_add_u32 v2, s41, v2
    s_waitcnt lgkmcnt(0)
    s_mov_b32 s20, s64
    s_mov_b32 s21, s65
    s_mov_b32 s22, 1048576
    s_mov_b32 s23, 0x00020000
    s_mov_b32 s4, s44
    s_mov_b32 s5, s45
    s_mov_b32 s6, 2560
    s_mov_b32 s7, 0x00020000
    buffer_load_dword v249, off, s[20:23], 0 sc1
    buffer_load_dword v244, v3, s[4:7], 0 offen offset:0
    buffer_load_dword v245, v3, s[4:7], 0 offen offset:256
    buffer_load_dword v246, v3, s[4:7], 0 offen offset:512
    buffer_load_dword v247, v3, s[4:7], 0 offen offset:768
    buffer_load_dword v248, v3, s[4:7], 0 offen offset:1024
    s_mov_b32 s16, s50
    s_mov_b32 s17, s51
    s_mov_b32 s18, 5242880
    s_mov_b32 s19, 0x00020000
    s_mov_b32 s32, 0
    buffer_load_dwordx4 v[16:19], v2, s[16:19], s32 offen
    s_add_u32 s32, s32, 32768
    buffer_load_dwordx4 v[20:23], v2, s[16:19], s32 offen
    s_add_u32 s32, s32, 32768
    buffer_load_dwordx4 v[24:27], v2, s[16:19], s32 offen
    s_add_u32 s32, s32, 32768
    buffer_load_dwordx4 v[28:31], v2, s[16:19], s32 offen
    s_add_u32 s32, s32, 32768
    buffer_load_dwordx4 v[32:35], v2, s[16:19], s32 offen
    s_add_u32 s32, s32, 32768
    buffer_load_dwordx4 v[36:39], v2, s[16:19], s32 offen
    s_add_u32 s32, s32, 32768
    buffer_load_dwordx4 v[40:43], v2, s[16:19], s32 offen
    s_add_u32 s32, s32, 32768
    buffer_load_dwordx4 v[44:47], v2, s[16:19], s32 offen
    s_add_u32 s32, s32, 32768
    buffer_load_dwordx4 v[48:51], v2, s[16:19], s32 offen
    s_add_u32 s32, s32, 32768
    buffer_load_dwordx4 v[52:55], v2, s[16:19], s32 offen
    s_add_u32 s32, s32, 32768
    buffer_load_dwordx4 v[56:59], v2, s[16:19], s32 offen
    s_add_u32 s32, s32, 32768
    buffer_load_dwordx4 v[60:63], v2, s[16:19], s32 offen
    s_add_u32 s32, s32, 32768
    buffer_load_dwordx4 v[64:67], v2, s[16:19], s32 offen
    s_add_u32 s32, s32, 32768
    buffer_load_dwordx4 v[68:71], v2, s[16:19], s32 offen
    s_add_u32 s32, s32, 32768
    buffer_load_dwordx4 v[72:75], v2, s[16:19], s32 offen
    s_add_u32 s32, s32, 32768
    buffer_load_dwordx4 v[76:79], v2, s[16:19], s32 offen
    s_add_u32 s32, s32, 32768
    buffer_load_dwordx4 v[80:83], v2, s[16:19], s32 offen
    s_add_u32 s32, s32, 32768
    buffer_load_dwordx4 v[84:87], v2, s[16:19], s32 offen
    s_add_u32 s32, s32, 32768
    buffer_load_dwordx4 v[88:91], v2, s[16:19], s32 offen
    s_add_u32 s32, s32, 32768
    buffer_load_dwordx4 v[92:95], v2, s[16:19], s32 offen
    s_add_u32 s8, s46, s40
    s_addc_u32 s9, s47, 0
    s_mov_b32 s10, 32768
    s_mov_b32 s11, 0x00020000
    s_add_u32 s12, s48, s40
    s_addc_u32 s13, s49, 0
    s_mov_b32 s14, 32768
    s_mov_b32 s15, 0x00020000
    s_mul_i32 s43, s2, 1
    s_mul_i32 s42, s3, 4
    s_add_u32 s43, s43, s42
    s_lshl_b32 s43, s43, 10
    s_add_u32 s32, s43, 0
    s_and_b32 s32, s32, 0x7c00
    buffer_load_dwordx4 v[96:99], v1, s[8:11], s32 offen nt
    s_add_u32 s32, s43, 1024
    s_and_b32 s32, s32, 0x7c00
    buffer_load_dwordx4 v[100:103], v1, s[8:11], s32 offen nt
    s_add_u32 s32, s43, 2048
    s_and_b32 s32, s32, 0x7c00
    buffer_load_dwordx4 v[104:107], v1, s[8:11], s32 offen nt
    s_add_u32 s32, s43, 3072
    s_and_b32 s32, s32, 0x7c00
    buffer_load_dwordx4 v[108:111], v1, s[8:11], s32 offen nt
    s_waitcnt vmcnt(24)
    v_readfirstlane_b32 s36, v249
    v_lshlrev_b32 v224, 16, v244
    v_and_b32 v225, s39, v244
    v_lshlrev_b32 v226, 16, v245
    v_and_b32 v227, s39, v245
    v_lshlrev_b32 v228, 16, v246
    v_and_b32 v229, s39, v246
    v_lshlrev_b32 v230, 16, v247
    v_and_b32 v231, s39, v247
    v_lshlrev_b32 v232, 16, v248
    v_and_b32 v233, s39, v248
    s_add_u32 s36, s36, 0x3B5D7F91
    s_and_b32 s90, s36, 0xff
    s_bfe_u32 s91, s36, 0x80008
    s_bfe_u32 s92, s36, 0x80010
    s_lshr_b32 s93, s36, 24
    s_and_b32 s94, s36, 0xffff
    s_lshr_b32 s95, s36, 16
    s_mov_b32 s96, 0xffffff00
    v_add_f32 v250, v224, v225
    v_mul_f32 v251, v224, v224
    v_fmac_f32 v251, v225, v225
    v_add_f32 v250, v250, v226
    v_fmac_f32 v251, v226, v226
    v_add_f32 v250, v250, v227
    v_fmac_f32 v251, v227, v227
    v_add_f32 v250, v250, v228
    v_fmac_f32 v251, v228, v228
    v_add_f32 v250, v250, v229
    v_fmac_f32 v251, v229, v229
    v_add_f32 v250, v250, v230
    v_fmac_f32 v251, v230, v230
    v_add_f32 v250, v250, v231
    v_fmac_f32 v251, v231, v231
    v_add_f32 v250, v250, v232
    v_fmac_f32 v251, v232, v232
    v_add_f32 v250, v250, v233
    v_fmac_f32 v251, v233, v233
    s_nop 0
    v_add_f32_dpp v250, v250, v250 row_ror:8 row_mask:0xf bank_mask:0xf
    v_add_f32_dpp v251, v251, v251 row_ror:8 row_mask:0xf bank_mask:0xf
    s_nop 0
    v_add_f32_dpp v250, v250, v250 row_ror:4 row_mask:0xf bank_mask:0xf
    v_add_f32_dpp v251, v251, v251 row_ror:4 row_mask:0xf bank_mask:0xf
    s_nop 0
    v_add_f32_dpp v250, v250, v250 row_ror:2 row_mask:0xf bank_mask:0xf
    v_add_f32_dpp v251, v251, v251 row_ror:2 row_mask:0xf bank_mask:0xf
    s_nop 0
    v_add_f32_dpp v250, v250, v250 row_ror:1 row_mask:0xf bank_mask:0xf
    v_add_f32_dpp v251, v251, v251 row_ror:1 row_mask:0xf bank_mask:0xf
    v_mov_b32 v252, v250
    v_mov_b32 v253, v251
    s_nop 0
    v_permlane16_swap_b32 v250, v252
    v_permlane16_swap_b32 v251, v253
    v_add_f32 v250, v250, v252
    v_add_f32 v251, v251, v253
    v_mov_b32 v252, v250
    v_mov_b32 v253, v251
    s_nop 0
    v_permlane32_swap_b32 v250, v252
    v_permlane32_swap_b32 v251, v253
    v_add_f32 v250, v250, v252
    v_add_f32 v251, v251, v253
    v_mul_f32 v250, s71, v250
    v_mul_f32 v251, s71, v251
    v_fma_f32 v251, -v250, v250, v251
    v_cvt_pk_bf16_f32 v252, v250, v251
    v_lshlrev_b32 v250, 16, v252
    v_and_b32 v251, s39, v252
    v_add_f32 v251, 0x3727c5ac, v251
    v_cvt_pk_bf16_f32 v251, v251, v251
    v_and_b32 v251, s39, v251
    v_sqrt_f32 v251, v251
    s_nop 0
    v_cvt_pk_bf16_f32 v251, v251, v251
    v_and_b32 v251, s39, v251
    v_rcp_f32 v251, v251
    v_sub_f32 v224, v224, v250
    v_sub_f32 v225, v225, v250
    v_sub_f32 v226, v226, v250
    v_sub_f32 v227, v227, v250
    v_sub_f32 v228, v228, v250
    v_sub_f32 v229, v229, v250
    v_sub_f32 v230, v230, v250
    v_sub_f32 v231, v231, v250
    v_sub_f32 v232, v232, v250
    v_sub_f32 v233, v233, v250
    v_cvt_pk_bf16_f32 v252, v224, v225
    v_lshlrev_b32 v224, 16, v252
    v_and_b32 v225, s39, v252
    v_cvt_pk_bf16_f32 v252, v226, v227
    v_lshlrev_b32 v226, 16, v252
    v_and_b32 v227, s39, v252
    v_cvt_pk_bf16_f32 v252, v228, v229
    v_lshlrev_b32 v228, 16, v252
    v_and_b32 v229, s39, v252
    v_cvt_pk_bf16_f32 v252, v230, v231
    v_lshlrev_b32 v230, 16, v252
    v_and_b32 v231, s39, v252
    v_cvt_pk_bf16_f32 v252, v232, v233
    v_lshlrev_b32 v232, 16, v252
    v_and_b32 v233, s39, v252
    v_mul_f32 v224, v224, v251
    v_mul_f32 v225, v225, v251
    v_mul_f32 v226, v226, v251
    v_mul_f32 v227, v227, v251
    v_mul_f32 v228, v228, v251
    v_mul_f32 v229, v229, v251
    v_mul_f32 v230, v230, v251
    v_mul_f32 v231, v231, v251
    v_mul_f32 v232, v232, v251
    v_mul_f32 v233, v233, v251
    v_cvt_pk_bf16_f32 v252, v224, v225
    v_lshlrev_b32 v224, 16, v252
    v_and_b32 v225, s39, v252
    v_cvt_pk_bf16_f32 v252, v226, v227
    v_lshlrev_b32 v226, 16, v252
    v_and_b32 v227, s39, v252
    v_cvt_pk_bf16_f32 v252, v228, v229
    v_lshlrev_b32 v228, 16, v252
    v_and_b32 v229, s39, v252
    v_cvt_pk_bf16_f32 v252, v230, v231
    v_lshlrev_b32 v230, 16, v252
    v_and_b32 v231, s39, v252
    v_cvt_pk_bf16_f32 v252, v232, v233
    v_lshlrev_b32 v232, 16, v252
    v_and_b32 v233, s39, v252
    s_mul_i32 s41, s3, 2560
    v_lshlrev_b32 v3, 3, v0
    v_add_u32 v3, s41, v3
    ds_write_b64 v3, v[224:225] offset:0
    ds_write_b64 v3, v[226:227] offset:512
    ds_write_b64 v3, v[228:229] offset:1024
    ds_write_b64 v3, v[230:231] offset:1536
    ds_write_b64 v3, v[232:233] offset:2048
    s_mul_i32 s41, s3, 2880
    s_nop 0
    v_lshlrev_b32 v3, 2, v254
    v_add_u32 v3, s41, v3
    ds_read2_b32 v[224:225], v3 offset0:0 offset1:4
    ds_read2_b32 v[226:227], v3 offset0:8 offset1:12
    ds_read2_b32 v[228:229], v3 offset0:16 offset1:20
    ds_read2_b32 v[230:231], v3 offset0:24 offset1:28
    ds_read2_b32 v[232:233], v3 offset0:32 offset1:36
    ds_read2_b32 v[234:235], v3 offset0:40 offset1:44
    ds_read2_b32 v[236:237], v3 offset0:48 offset1:52
    ds_read2_b32 v[238:239], v3 offset0:56 offset1:60
    ds_read2_b32 v[240:241], v3 offset0:64 offset1:68
    ds_read2_b32 v[242:243], v3 offset0:72 offset1:76
    s_waitcnt lgkmcnt(0)
    v_cvt_pk_bf16_f32 v244, v224, v225
    v_cvt_pk_bf16_f32 v245, v226, v227
    v_cvt_pk_bf16_f32 v246, v228, v229
    v_cvt_pk_bf16_f32 v247, v230, v231
    v_cvt_pk_bf16_f32 v248, v232, v233
    v_cvt_pk_bf16_f32 v249, v234, v235
    v_cvt_pk_bf16_f32 v250, v236, v237
    v_cvt_pk_bf16_f32 v251, v238, v239
    v_cvt_pk_bf16_f32 v252, v240, v241
    v_cvt_pk_bf16_f32 v253, v242, v243
    s_add_u32 s32, s43, 4096
    s_and_b32 s32, s32, 0x7c00
    buffer_load_dwordx4 v[112:115], v1, s[8:11], s32 offen nt
    s_add_u32 s32, s43, 5120
    s_and_b32 s32, s32, 0x7c00
    buffer_load_dwordx4 v[116:119], v1, s[8:11], s32 offen nt
    s_add_u32 s32, s43, 6144
    s_and_b32 s32, s32, 0x7c00
    buffer_load_dwordx4 v[120:123], v1, s[8:11], s32 offen nt
    s_add_u32 s32, s43, 7168
    s_and_b32 s32, s32, 0x7c00
    buffer_load_dwordx4 v[124:127], v1, s[8:11], s32 offen nt
    v_mov_b32 v8, 0
    v_mov_b32 v9, 0
    v_mov_b32 v10, 0
    v_mov_b32 v11, 0
    v_mov_b32 v12, 0
    v_mov_b32 v13, 0
    v_mov_b32 v14, 0
    v_mov_b32 v15, 0
    s_waitcnt vmcnt(26)
    v_perm_b32 v224, v20, v16, s37
    v_perm_b32 v225, v20, v16, s38
    v_perm_b32 v226, v21, v17, s37
    v_perm_b32 v227, v21, v17, s38
    v_perm_b32 v228, v22, v18, s37
    v_perm_b32 v229, v22, v18, s38
    v_perm_b32 v230, v23, v19, s37
    v_perm_b32 v231, v23, v19, s38
    v_dot2_f32_bf16 v8, v224, v244, v8
    v_dot2_f32_bf16 v9, v225, v244, v9
    v_dot2_f32_bf16 v10, v226, v244, v10
    v_dot2_f32_bf16 v11, v227, v244, v11
    v_dot2_f32_bf16 v12, v228, v244, v12
    v_dot2_f32_bf16 v13, v229, v244, v13
    v_dot2_f32_bf16 v14, v230, v244, v14
    v_dot2_f32_bf16 v15, v231, v244, v15
    s_waitcnt vmcnt(24)
    v_perm_b32 v224, v28, v24, s37
    v_perm_b32 v225, v28, v24, s38
    v_perm_b32 v226, v29, v25, s37
    v_perm_b32 v227, v29, v25, s38
    v_perm_b32 v228, v30, v26, s37
    v_perm_b32 v229, v30, v26, s38
    v_perm_b32 v230, v31, v27, s37
    v_perm_b32 v231, v31, v27, s38
    v_dot2_f32_bf16 v8, v224, v245, v8
    v_dot2_f32_bf16 v9, v225, v245, v9
    v_dot2_f32_bf16 v10, v226, v245, v10
    v_dot2_f32_bf16 v11, v227, v245, v11
    v_dot2_f32_bf16 v12, v228, v245, v12
    v_dot2_f32_bf16 v13, v229, v245, v13
    v_dot2_f32_bf16 v14, v230, v245, v14
    v_dot2_f32_bf16 v15, v231, v245, v15
    s_waitcnt vmcnt(22)
    v_perm_b32 v224, v36, v32, s37
    v_perm_b32 v225, v36, v32, s38
    v_perm_b32 v226, v37, v33, s37
    v_perm_b32 v227, v37, v33, s38
    v_perm_b32 v228, v38, v34, s37
    v_perm_b32 v229, v38, v34, s38
    v_perm_b32 v230, v39, v35, s37
    v_perm_b32 v231, v39, v35, s38
    v_dot2_f32_bf16 v8, v224, v246, v8
    v_dot2_f32_bf16 v9, v225, v246, v9
    v_dot2_f32_bf16 v10, v226, v246, v10
    v_dot2_f32_bf16 v11, v227, v246, v11
    v_dot2_f32_bf16 v12, v228, v246, v12
    v_dot2_f32_bf16 v13, v229, v246, v13
    v_dot2_f32_bf16 v14, v230, v246, v14
    v_dot2_f32_bf16 v15, v231, v246, v15
    s_waitcnt vmcnt(20)
    v_perm_b32 v224, v44, v40, s37
    v_perm_b32 v225, v44, v40, s38
    v_perm_b32 v226, v45, v41, s37
    v_perm_b32 v227, v45, v41, s38
    v_perm_b32 v228, v46, v42, s37
    v_perm_b32 v229, v46, v42, s38
    v_perm_b32 v230, v47, v43, s37
    v_perm_b32 v231, v47, v43, s38
    v_dot2_f32_bf16 v8, v224, v247, v8
    v_dot2_f32_bf16 v9, v225, v247, v9
    v_dot2_f32_bf16 v10, v226, v247, v10
    v_dot2_f32_bf16 v11, v227, v247, v11
    v_dot2_f32_bf16 v12, v228, v247, v12
    v_dot2_f32_bf16 v13, v229, v247, v13
    v_dot2_f32_bf16 v14, v230, v247, v14
    v_dot2_f32_bf16 v15, v231, v247, v15
    s_waitcnt vmcnt(18)
    v_perm_b32 v224, v52, v48, s37
    v_perm_b32 v225, v52, v48, s38
    v_perm_b32 v226, v53, v49, s37
    v_perm_b32 v227, v53, v49, s38
    v_perm_b32 v228, v54, v50, s37
    v_perm_b32 v229, v54, v50, s38
    v_perm_b32 v230, v55, v51, s37
    v_perm_b32 v231, v55, v51, s38
    v_dot2_f32_bf16 v8, v224, v248, v8
    v_dot2_f32_bf16 v9, v225, v248, v9
    v_dot2_f32_bf16 v10, v226, v248, v10
    v_dot2_f32_bf16 v11, v227, v248, v11
    v_dot2_f32_bf16 v12, v228, v248, v12
    v_dot2_f32_bf16 v13, v229, v248, v13
    v_dot2_f32_bf16 v14, v230, v248, v14
    v_dot2_f32_bf16 v15, v231, v248, v15
    s_waitcnt vmcnt(16)
    v_perm_b32 v224, v60, v56, s37
    v_perm_b32 v225, v60, v56, s38
    v_perm_b32 v226, v61, v57, s37
    v_perm_b32 v227, v61, v57, s38
    v_perm_b32 v228, v62, v58, s37
    v_perm_b32 v229, v62, v58, s38
    v_perm_b32 v230, v63, v59, s37
    v_perm_b32 v231, v63, v59, s38
    v_dot2_f32_bf16 v8, v224, v249, v8
    v_dot2_f32_bf16 v9, v225, v249, v9
    v_dot2_f32_bf16 v10, v226, v249, v10
    v_dot2_f32_bf16 v11, v227, v249, v11
    v_dot2_f32_bf16 v12, v228, v249, v12
    v_dot2_f32_bf16 v13, v229, v249, v13
    v_dot2_f32_bf16 v14, v230, v249, v14
    v_dot2_f32_bf16 v15, v231, v249, v15
    s_waitcnt vmcnt(14)
    v_perm_b32 v224, v68, v64, s37
    v_perm_b32 v225, v68, v64, s38
    v_perm_b32 v226, v69, v65, s37
    v_perm_b32 v227, v69, v65, s38
    v_perm_b32 v228, v70, v66, s37
    v_perm_b32 v229, v70, v66, s38
    v_perm_b32 v230, v71, v67, s37
    v_perm_b32 v231, v71, v67, s38
    v_dot2_f32_bf16 v8, v224, v250, v8
    v_dot2_f32_bf16 v9, v225, v250, v9
    v_dot2_f32_bf16 v10, v226, v250, v10
    v_dot2_f32_bf16 v11, v227, v250, v11
    v_dot2_f32_bf16 v12, v228, v250, v12
    v_dot2_f32_bf16 v13, v229, v250, v13
    v_dot2_f32_bf16 v14, v230, v250, v14
    v_dot2_f32_bf16 v15, v231, v250, v15
    s_waitcnt vmcnt(12)
    v_perm_b32 v224, v76, v72, s37
    v_perm_b32 v225, v76, v72, s38
    v_perm_b32 v226, v77, v73, s37
    v_perm_b32 v227, v77, v73, s38
    v_perm_b32 v228, v78, v74, s37
    v_perm_b32 v229, v78, v74, s38
    v_perm_b32 v230, v79, v75, s37
    v_perm_b32 v231, v79, v75, s38
    v_dot2_f32_bf16 v8, v224, v251, v8
    v_dot2_f32_bf16 v9, v225, v251, v9
    v_dot2_f32_bf16 v10, v226, v251, v10
    v_dot2_f32_bf16 v11, v227, v251, v11
    v_dot2_f32_bf16 v12, v228, v251, v12
    v_dot2_f32_bf16 v13, v229, v251, v13
    v_dot2_f32_bf16 v14, v230, v251, v14
    v_dot2_f32_bf16 v15, v231, v251, v15
    s_waitcnt vmcnt(10)
    v_perm_b32 v224, v84, v80, s37
    v_perm_b32 v225, v84, v80, s38
    v_perm_b32 v226, v85, v81, s37
    v_perm_b32 v227, v85, v81, s38
    v_perm_b32 v228, v86, v82, s37
    v_perm_b32 v229, v86, v82, s38
    v_perm_b32 v230, v87, v83, s37
    v_perm_b32 v231, v87, v83, s38
    v_dot2_f32_bf16 v8, v224, v252, v8
    v_dot2_f32_bf16 v9, v225, v252, v9
    v_dot2_f32_bf16 v10, v226, v252, v10
    v_dot2_f32_bf16 v11, v227, v252, v11
    v_dot2_f32_bf16 v12, v228, v252, v12
    v_dot2_f32_bf16 v13, v229, v252, v13
    v_dot2_f32_bf16 v14, v230, v252, v14
    v_dot2_f32_bf16 v15, v231, v252, v15
    s_waitcnt vmcnt(8)
    v_perm_b32 v224, v92, v88, s37
    v_perm_b32 v225, v92, v88, s38
    v_perm_b32 v226, v93, v89, s37
    v_perm_b32 v227, v93, v89, s38
    v_perm_b32 v228, v94, v90, s37
    v_perm_b32 v229, v94, v90, s38
    v_perm_b32 v230, v95, v91, s37
    v_perm_b32 v231, v95, v91, s38
    v_dot2_f32_bf16 v8, v224, v253, v8
    v_dot2_f32_bf16 v9, v225, v253, v9
    v_dot2_f32_bf16 v10, v226, v253, v10
    v_dot2_f32_bf16 v11, v227, v253, v11
    v_dot2_f32_bf16 v12, v228, v253, v12
    v_dot2_f32_bf16 v13, v229, v253, v13
    v_dot2_f32_bf16 v14, v230, v253, v14
    v_dot2_f32_bf16 v15, v231, v253, v15
    s_add_u32 s32, s43, 8192
    s_and_b32 s32, s32, 0x7c00
    buffer_load_dwordx4 v[128:131], v1, s[8:11], s32 offen nt
    s_add_u32 s32, s43, 9216
    s_and_b32 s32, s32, 0x7c00
    buffer_load_dwordx4 v[132:135], v1, s[8:11], s32 offen nt
    s_add_u32 s32, s43, 10240
    s_and_b32 s32, s32, 0x7c00
    buffer_load_dwordx4 v[136:139], v1, s[8:11], s32 offen nt
    s_add_u32 s32, s43, 11264
    s_and_b32 s32, s32, 0x7c00
    buffer_load_dwordx4 v[140:143], v1, s[8:11], s32 offen nt
    s_add_u32 s32, s43, 12288
    s_and_b32 s32, s32, 0x7c00
    buffer_load_dwordx4 v[144:147], v1, s[8:11], s32 offen nt
    s_add_u32 s32, s43, 13312
    s_and_b32 s32, s32, 0x7c00
    buffer_load_dwordx4 v[148:151], v1, s[8:11], s32 offen nt
    s_add_u32 s32, s43, 14336
    s_and_b32 s32, s32, 0x7c00
    buffer_load_dwordx4 v[152:155], v1, s[8:11], s32 offen nt
    s_add_u32 s32, s43, 15360
    s_and_b32 s32, s32, 0x7c00
    buffer_load_dwordx4 v[156:159], v1, s[8:11], s32 offen nt
    v_permlane32_swap_b32 v8, v12
    v_permlane32_swap_b32 v9, v13
    v_permlane32_swap_b32 v10, v14
    v_permlane32_swap_b32 v11, v15
    v_add_f32 v8, v8, v12
    v_add_f32 v9, v9, v13
    v_add_f32 v10, v10, v14
    v_add_f32 v11, v11, v15
    s_nop 0
    v_permlane16_swap_b32 v8, v10
    v_permlane16_swap_b32 v9, v11
    v_add_f32 v8, v8, v10
    v_add_f32 v9, v9, v11
    v_lshlrev_b32 v3, 5, v255
    v_lshl_add_u32 v3, v254, 3, v3
    s_lshl_b32 s41, s3, 9
    v_add_u32 v253, s41, v3
    ds_write_b64 v253, v[8:9] offset:20480
    s_waitcnt lgkmcnt(0)
    s_barrier
    ds_read_b64 v[224:225], v3 offset:20480
    ds_read_b64 v[226:227], v3 offset:20992
    ds_read_b64 v[228:229], v3 offset:21504
    ds_read_b64 v[230:231], v3 offset:22016
    ds_read_b64 v[232:233], v3 offset:22528
    ds_read_b64 v[234:235], v3 offset:23040
    ds_read_b64 v[236:237], v3 offset:23552
    ds_read_b64 v[238:239], v3 offset:24064
    s_waitcnt lgkmcnt(0)
    v_add_f32 v224, v224, v232
    v_add_f32 v225, v225, v233
    v_add_f32 v226, v226, v234
    v_add_f32 v227, v227, v235
    v_add_f32 v228, v228, v236
    v_add_f32 v229, v229, v237
    v_add_f32 v230, v230, v238
    v_add_f32 v231, v231, v239
    v_add_f32 v224, v224, v228
    v_add_f32 v225, v225, v229
    v_add_f32 v226, v226, v230
    v_add_f32 v227, v227, v231
    v_add_f32 v224, v224, v226
    v_add_f32 v225, v225, v227
    v_cvt_pk_bf16_f32 v4, v224, v225
    v_mov_b32 v5, v4
    s_nop 1
    v_permlane16_swap_b32 v4, v5
    v_mov_b32 v6, v4
    v_mov_b32 v7, v5
    s_nop 0
    v_permlane32_swap_b32 v4, v6
    v_permlane32_swap_b32 v5, v7
    s_setprio 3
    s_waitcnt vmcnt(12)
    v_dot2_f32_bf16 v224, v96, v4, 0
    v_dot2_f32_bf16 v225, v100, v4, 0
    v_dot2_f32_bf16 v226, v104, v4, 0
    v_dot2_f32_bf16 v227, v108, v4, 0
    v_dot2_f32_bf16 v224, v97, v5, v224
    v_dot2_f32_bf16 v225, v101, v5, v225
    v_dot2_f32_bf16 v226, v105, v5, v226
    v_dot2_f32_bf16 v227, v109, v5, v227
    v_dot2_f32_bf16 v224, v98, v6, v224
    v_dot2_f32_bf16 v225, v102, v6, v225
    v_dot2_f32_bf16 v226, v106, v6, v226
    v_dot2_f32_bf16 v227, v110, v6, v227
    v_dot2_f32_bf16 v224, v99, v7, v224
    v_dot2_f32_bf16 v225, v103, v7, v225
    v_dot2_f32_bf16 v226, v107, v7, v226
    v_dot2_f32_bf16 v227, v111, v7, v227
    s_add_u32 s32, s43, 16384
    s_and_b32 s32, s32, 0x7c00
    buffer_load_dwordx4 v[160:163], v1, s[8:11], s32 offen nt
    s_add_u32 s32, s43, 17408
    s_and_b32 s32, s32, 0x7c00
    buffer_load_dwordx4 v[164:167], v1, s[8:11], s32 offen nt
    s_add_u32 s32, s43, 18432
    s_and_b32 s32, s32, 0x7c00
    buffer_load_dwordx4 v[168:171], v1, s[8:11], s32 offen nt
    s_add_u32 s32, s43, 19456
    s_and_b32 s32, s32, 0x7c00
    buffer_load_dwordx4 v[172:175], v1, s[8:11], s32 offen nt
    s_waitcnt vmcnt(12)
    v_dot2_f32_bf16 v228, v112, v4, 0
    v_dot2_f32_bf16 v229, v116, v4, 0
    v_dot2_f32_bf16 v230, v120, v4, 0
    v_dot2_f32_bf16 v231, v124, v4, 0
    v_dot2_f32_bf16 v228, v113, v5, v228
    v_dot2_f32_bf16 v229, v117, v5, v229
    v_dot2_f32_bf16 v230, v121, v5, v230
    v_dot2_f32_bf16 v231, v125, v5, v231
    v_dot2_f32_bf16 v228, v114, v6, v228
    v_dot2_f32_bf16 v229, v118, v6, v229
    v_dot2_f32_bf16 v230, v122, v6, v230
    v_dot2_f32_bf16 v231, v126, v6, v231
    v_dot2_f32_bf16 v228, v115, v7, v228
    v_dot2_f32_bf16 v229, v119, v7, v229
    v_dot2_f32_bf16 v230, v123, v7, v230
    v_dot2_f32_bf16 v231, v127, v7, v231
    s_add_u32 s32, s43, 20480
    s_and_b32 s32, s32, 0x7c00
    buffer_load_dwordx4 v[176:179], v1, s[8:11], s32 offen nt
    s_add_u32 s32, s43, 21504
    s_and_b32 s32, s32, 0x7c00
    buffer_load_dwordx4 v[180:183], v1, s[8:11], s32 offen nt
    s_add_u32 s32, s43, 22528
    s_and_b32 s32, s32, 0x7c00
    buffer_load_dwordx4 v[184:187], v1, s[8:11], s32 offen nt
    s_add_u32 s32, s43, 23552
    s_and_b32 s32, s32, 0x7c00
    buffer_load_dwordx4 v[188:191], v1, s[8:11], s32 offen nt
    v_add_f32_dpp v224, v224, v224 row_ror:8 row_mask:0xf bank_mask:0x3
    v_add_f32_dpp v225, v225, v225 row_ror:8 row_mask:0xf bank_mask:0x3
    v_add_f32_dpp v226, v226, v226 row_ror:8 row_mask:0xf bank_mask:0x3
    v_add_f32_dpp v227, v227, v227 row_ror:8 row_mask:0xf bank_mask:0x3
    v_add_f32_dpp v224, v228, v228 row_ror:8 row_mask:0xf bank_mask:0xc
    v_add_f32_dpp v225, v229, v229 row_ror:8 row_mask:0xf bank_mask:0xc
    v_add_f32_dpp v226, v230, v230 row_ror:8 row_mask:0xf bank_mask:0xc
    v_add_f32_dpp v227, v231, v231 row_ror:8 row_mask:0xf bank_mask:0xc
    v_add_f32_dpp v232, v224, v224 row_shl:4 row_mask:0xf bank_mask:0x5
    v_add_f32_dpp v233, v225, v225 row_shl:4 row_mask:0xf bank_mask:0x5
    v_add_f32_dpp v232, v226, v226 row_shr:4 row_mask:0xf bank_mask:0xa
    v_add_f32_dpp v233, v227, v227 row_shr:4 row_mask:0xf bank_mask:0xa
    s_nop 0
    v_add_f32_dpp v232, v232, v232 quad_perm:[1,0,3,2] row_mask:0xf bank_mask:0xf
    v_add_f32_dpp v233, v233, v233 quad_perm:[1,0,3,2] row_mask:0xf bank_mask:0xf
    s_nop 0
    v_add_f32_dpp v232, v232, v232 quad_perm:[2,3,0,1] row_mask:0xf bank_mask:0xf
    v_add_f32_dpp v233, v233, v233 quad_perm:[2,3,0,1] row_mask:0xf bank_mask:0xf
    s_waitcnt vmcnt(12)
    v_dot2_f32_bf16 v224, v128, v4, 0
    v_dot2_f32_bf16 v225, v132, v4, 0
    v_dot2_f32_bf16 v226, v136, v4, 0
    v_dot2_f32_bf16 v227, v140, v4, 0
    v_dot2_f32_bf16 v224, v129, v5, v224
    v_dot2_f32_bf16 v225, v133, v5, v225
    v_dot2_f32_bf16 v226, v137, v5, v226
    v_dot2_f32_bf16 v227, v141, v5, v227
    v_dot2_f32_bf16 v224, v130, v6, v224
    v_dot2_f32_bf16 v225, v134, v6, v225
    v_dot2_f32_bf16 v226, v138, v6, v226
    v_dot2_f32_bf16 v227, v142, v6, v227
    v_dot2_f32_bf16 v224, v131, v7, v224
    v_dot2_f32_bf16 v225, v135, v7, v225
    v_dot2_f32_bf16 v226, v139, v7, v226
    v_dot2_f32_bf16 v227, v143, v7, v227
    s_add_u32 s32, s43, 24576
    s_and_b32 s32, s32, 0x7c00
    buffer_load_dwordx4 v[192:195], v1, s[8:11], s32 offen nt
    s_add_u32 s32, s43, 25600
    s_and_b32 s32, s32, 0x7c00
    buffer_load_dwordx4 v[196:199], v1, s[8:11], s32 offen nt
    s_add_u32 s32, s43, 26624
    s_and_b32 s32, s32, 0x7c00
    buffer_load_dwordx4 v[200:203], v1, s[8:11], s32 offen nt
    s_add_u32 s32, s43, 27648
    s_and_b32 s32, s32, 0x7c00
    buffer_load_dwordx4 v[204:207], v1, s[8:11], s32 offen nt
    s_waitcnt vmcnt(12)
    v_dot2_f32_bf16 v228, v144, v4, 0
    v_dot2_f32_bf16 v229, v148, v4, 0
    v_dot2_f32_bf16 v230, v152, v4, 0
    v_dot2_f32_bf16 v231, v156, v4, 0
    v_dot2_f32_bf16 v228, v145, v5, v228
    v_dot2_f32_bf16 v229, v149, v5, v229
    v_dot2_f32_bf16 v230, v153, v5, v230
    v_dot2_f32_bf16 v231, v157, v5, v231
    v_dot2_f32_bf16 v228, v146, v6, v228
    v_dot2_f32_bf16 v229, v150, v6, v229
    v_dot2_f32_bf16 v230, v154, v6, v230
    v_dot2_f32_bf16 v231, v158, v6, v231
    v_dot2_f32_bf16 v228, v147, v7, v228
    v_dot2_f32_bf16 v229, v151, v7, v229
    v_dot2_f32_bf16 v230, v155, v7, v230
    v_dot2_f32_bf16 v231, v159, v7, v231
    s_add_u32 s32, s43, 28672
    s_and_b32 s32, s32, 0x7c00
    buffer_load_dwordx4 v[208:211], v1, s[8:11], s32 offen nt
    s_add_u32 s32, s43, 29696
    s_and_b32 s32, s32, 0x7c00
    buffer_load_dwordx4 v[212:215], v1, s[8:11], s32 offen nt
    s_add_u32 s32, s43, 30720
    s_and_b32 s32, s32, 0x7c00
    buffer_load_dwordx4 v[216:219], v1, s[8:11], s32 offen nt
    s_add_u32 s32, s43, 31744
    s_and_b32 s32, s32, 0x7c00
    buffer_load_dwordx4 v[220:223], v1, s[8:11], s32 offen nt
    v_add_f32_dpp v224, v224, v224 row_ror:8 row_mask:0xf bank_mask:0x3
    v_add_f32_dpp v225, v225, v225 row_ror:8 row_mask:0xf bank_mask:0x3
    v_add_f32_dpp v226, v226, v226 row_ror:8 row_mask:0xf bank_mask:0x3
    v_add_f32_dpp v227, v227, v227 row_ror:8 row_mask:0xf bank_mask:0x3
    v_add_f32_dpp v224, v228, v228 row_ror:8 row_mask:0xf bank_mask:0xc
    v_add_f32_dpp v225, v229, v229 row_ror:8 row_mask:0xf bank_mask:0xc
    v_add_f32_dpp v226, v230, v230 row_ror:8 row_mask:0xf bank_mask:0xc
    v_add_f32_dpp v227, v231, v231 row_ror:8 row_mask:0xf bank_mask:0xc
    v_add_f32_dpp v234, v224, v224 row_shl:4 row_mask:0xf bank_mask:0x5
    v_add_f32_dpp v235, v225, v225 row_shl:4 row_mask:0xf bank_mask:0x5
    v_add_f32_dpp v234, v226, v226 row_shr:4 row_mask:0xf bank_mask:0xa
    v_add_f32_dpp v235, v227, v227 row_shr:4 row_mask:0xf bank_mask:0xa
    s_nop 0
    v_add_f32_dpp v234, v234, v234 quad_perm:[1,0,3,2] row_mask:0xf bank_mask:0xf
    v_add_f32_dpp v235, v235, v235 quad_perm:[1,0,3,2] row_mask:0xf bank_mask:0xf
    s_nop 0
    v_add_f32_dpp v234, v234, v234 quad_perm:[2,3,0,1] row_mask:0xf bank_mask:0xf
    v_add_f32_dpp v235, v235, v235 quad_perm:[2,3,0,1] row_mask:0xf bank_mask:0xf
    s_setprio 2
    s_waitcnt vmcnt(12)
    v_dot2_f32_bf16 v224, v160, v4, 0
    v_dot2_f32_bf16 v225, v164, v4, 0
    v_dot2_f32_bf16 v226, v168, v4, 0
    v_dot2_f32_bf16 v227, v172, v4, 0
    v_dot2_f32_bf16 v224, v161, v5, v224
    v_dot2_f32_bf16 v225, v165, v5, v225
    v_dot2_f32_bf16 v226, v169, v5, v226
    v_dot2_f32_bf16 v227, v173, v5, v227
    v_dot2_f32_bf16 v224, v162, v6, v224
    v_dot2_f32_bf16 v225, v166, v6, v225
    v_dot2_f32_bf16 v226, v170, v6, v226
    v_dot2_f32_bf16 v227, v174, v6, v227
    v_dot2_f32_bf16 v224, v163, v7, v224
    v_dot2_f32_bf16 v225, v167, v7, v225
    v_dot2_f32_bf16 v226, v171, v7, v226
    v_dot2_f32_bf16 v227, v175, v7, v227
    s_add_u32 s32, s43, 0
    s_and_b32 s32, s32, 0x7c00
    buffer_load_dwordx4 v[16:19], v1, s[12:15], s32 offen nt
    s_add_u32 s32, s43, 1024
    s_and_b32 s32, s32, 0x7c00
    buffer_load_dwordx4 v[20:23], v1, s[12:15], s32 offen nt
    s_add_u32 s32, s43, 2048
    s_and_b32 s32, s32, 0x7c00
    buffer_load_dwordx4 v[24:27], v1, s[12:15], s32 offen nt
    s_add_u32 s32, s43, 3072
    s_and_b32 s32, s32, 0x7c00
    buffer_load_dwordx4 v[28:31], v1, s[12:15], s32 offen nt
    s_waitcnt vmcnt(12)
    v_dot2_f32_bf16 v228, v176, v4, 0
    v_dot2_f32_bf16 v229, v180, v4, 0
    v_dot2_f32_bf16 v230, v184, v4, 0
    v_dot2_f32_bf16 v231, v188, v4, 0
    v_dot2_f32_bf16 v228, v177, v5, v228
    v_dot2_f32_bf16 v229, v181, v5, v229
    v_dot2_f32_bf16 v230, v185, v5, v230
    v_dot2_f32_bf16 v231, v189, v5, v231
    v_dot2_f32_bf16 v228, v178, v6, v228
    v_dot2_f32_bf16 v229, v182, v6, v229
    v_dot2_f32_bf16 v230, v186, v6, v230
    v_dot2_f32_bf16 v231, v190, v6, v231
    v_dot2_f32_bf16 v228, v179, v7, v228
    v_dot2_f32_bf16 v229, v183, v7, v229
    v_dot2_f32_bf16 v230, v187, v7, v230
    v_dot2_f32_bf16 v231, v191, v7, v231
    s_add_u32 s32, s43, 4096
    s_and_b32 s32, s32, 0x7c00
    buffer_load_dwordx4 v[32:35], v1, s[12:15], s32 offen nt
    s_add_u32 s32, s43, 5120
    s_and_b32 s32, s32, 0x7c00
    buffer_load_dwordx4 v[36:39], v1, s[12:15], s32 offen nt
    s_add_u32 s32, s43, 6144
    s_and_b32 s32, s32, 0x7c00
    buffer_load_dwordx4 v[40:43], v1, s[12:15], s32 offen nt
    s_add_u32 s32, s43, 7168
    s_and_b32 s32, s32, 0x7c00
    buffer_load_dwordx4 v[44:47], v1, s[12:15], s32 offen nt
    v_add_f32_dpp v224, v224, v224 row_ror:8 row_mask:0xf bank_mask:0x3
    v_add_f32_dpp v225, v225, v225 row_ror:8 row_mask:0xf bank_mask:0x3
    v_add_f32_dpp v226, v226, v226 row_ror:8 row_mask:0xf bank_mask:0x3
    v_add_f32_dpp v227, v227, v227 row_ror:8 row_mask:0xf bank_mask:0x3
    v_add_f32_dpp v224, v228, v228 row_ror:8 row_mask:0xf bank_mask:0xc
    v_add_f32_dpp v225, v229, v229 row_ror:8 row_mask:0xf bank_mask:0xc
    v_add_f32_dpp v226, v230, v230 row_ror:8 row_mask:0xf bank_mask:0xc
    v_add_f32_dpp v227, v231, v231 row_ror:8 row_mask:0xf bank_mask:0xc
    v_add_f32_dpp v236, v224, v224 row_shl:4 row_mask:0xf bank_mask:0x5
    v_add_f32_dpp v237, v225, v225 row_shl:4 row_mask:0xf bank_mask:0x5
    v_add_f32_dpp v236, v226, v226 row_shr:4 row_mask:0xf bank_mask:0xa
    v_add_f32_dpp v237, v227, v227 row_shr:4 row_mask:0xf bank_mask:0xa
    s_nop 0
    v_add_f32_dpp v236, v236, v236 quad_perm:[1,0,3,2] row_mask:0xf bank_mask:0xf
    v_add_f32_dpp v237, v237, v237 quad_perm:[1,0,3,2] row_mask:0xf bank_mask:0xf
    s_nop 0
    v_add_f32_dpp v236, v236, v236 quad_perm:[2,3,0,1] row_mask:0xf bank_mask:0xf
    v_add_f32_dpp v237, v237, v237 quad_perm:[2,3,0,1] row_mask:0xf bank_mask:0xf
    s_waitcnt vmcnt(12)
    v_dot2_f32_bf16 v224, v192, v4, 0
    v_dot2_f32_bf16 v225, v196, v4, 0
    v_dot2_f32_bf16 v226, v200, v4, 0
    v_dot2_f32_bf16 v227, v204, v4, 0
    v_dot2_f32_bf16 v224, v193, v5, v224
    v_dot2_f32_bf16 v225, v197, v5, v225
    v_dot2_f32_bf16 v226, v201, v5, v226
    v_dot2_f32_bf16 v227, v205, v5, v227
    v_dot2_f32_bf16 v224, v194, v6, v224
    v_dot2_f32_bf16 v225, v198, v6, v225
    v_dot2_f32_bf16 v226, v202, v6, v226
    v_dot2_f32_bf16 v227, v206, v6, v227
    v_dot2_f32_bf16 v224, v195, v7, v224
    v_dot2_f32_bf16 v225, v199, v7, v225
    v_dot2_f32_bf16 v226, v203, v7, v226
    v_dot2_f32_bf16 v227, v207, v7, v227
    s_add_u32 s32, s43, 8192
    s_and_b32 s32, s32, 0x7c00
    buffer_load_dwordx4 v[48:51], v1, s[12:15], s32 offen nt
    s_add_u32 s32, s43, 9216
    s_and_b32 s32, s32, 0x7c00
    buffer_load_dwordx4 v[52:55], v1, s[12:15], s32 offen nt
    s_add_u32 s32, s43, 10240
    s_and_b32 s32, s32, 0x7c00
    buffer_load_dwordx4 v[56:59], v1, s[12:15], s32 offen nt
    s_add_u32 s32, s43, 11264
    s_and_b32 s32, s32, 0x7c00
    buffer_load_dwordx4 v[60:63], v1, s[12:15], s32 offen nt
    s_waitcnt vmcnt(12)
    v_dot2_f32_bf16 v228, v208, v4, 0
    v_dot2_f32_bf16 v229, v212, v4, 0
    v_dot2_f32_bf16 v230, v216, v4, 0
    v_dot2_f32_bf16 v231, v220, v4, 0
    v_dot2_f32_bf16 v228, v209, v5, v228
    v_dot2_f32_bf16 v229, v213, v5, v229
    v_dot2_f32_bf16 v230, v217, v5, v230
    v_dot2_f32_bf16 v231, v221, v5, v231
    v_dot2_f32_bf16 v228, v210, v6, v228
    v_dot2_f32_bf16 v229, v214, v6, v229
    v_dot2_f32_bf16 v230, v218, v6, v230
    v_dot2_f32_bf16 v231, v222, v6, v231
    v_dot2_f32_bf16 v228, v211, v7, v228
    v_dot2_f32_bf16 v229, v215, v7, v229
    v_dot2_f32_bf16 v230, v219, v7, v230
    v_dot2_f32_bf16 v231, v223, v7, v231
    s_add_u32 s32, s43, 12288
    s_and_b32 s32, s32, 0x7c00
    buffer_load_dwordx4 v[64:67], v1, s[12:15], s32 offen nt
    s_add_u32 s32, s43, 13312
    s_and_b32 s32, s32, 0x7c00
    buffer_load_dwordx4 v[68:71], v1, s[12:15], s32 offen nt
    s_add_u32 s32, s43, 14336
    s_and_b32 s32, s32, 0x7c00
    buffer_load_dwordx4 v[72:75], v1, s[12:15], s32 offen nt
    s_add_u32 s32, s43, 15360
    s_and_b32 s32, s32, 0x7c00
    buffer_load_dwordx4 v[76:79], v1, s[12:15], s32 offen nt
    v_add_f32_dpp v224, v224, v224 row_ror:8 row_mask:0xf bank_mask:0x3
    v_add_f32_dpp v225, v225, v225 row_ror:8 row_mask:0xf bank_mask:0x3
    v_add_f32_dpp v226, v226, v226 row_ror:8 row_mask:0xf bank_mask:0x3
    v_add_f32_dpp v227, v227, v227 row_ror:8 row_mask:0xf bank_mask:0x3
    v_add_f32_dpp v224, v228, v228 row_ror:8 row_mask:0xf bank_mask:0xc
    v_add_f32_dpp v225, v229, v229 row_ror:8 row_mask:0xf bank_mask:0xc
    v_add_f32_dpp v226, v230, v230 row_ror:8 row_mask:0xf bank_mask:0xc
    v_add_f32_dpp v227, v231, v231 row_ror:8 row_mask:0xf bank_mask:0xc
    v_add_f32_dpp v238, v224, v224 row_shl:4 row_mask:0xf bank_mask:0x5
    v_add_f32_dpp v239, v225, v225 row_shl:4 row_mask:0xf bank_mask:0x5
    v_add_f32_dpp v238, v226, v226 row_shr:4 row_mask:0xf bank_mask:0xa
    v_add_f32_dpp v239, v227, v227 row_shr:4 row_mask:0xf bank_mask:0xa
    s_nop 0
    v_add_f32_dpp v238, v238, v238 quad_perm:[1,0,3,2] row_mask:0xf bank_mask:0xf
    v_add_f32_dpp v239, v239, v239 quad_perm:[1,0,3,2] row_mask:0xf bank_mask:0xf
    s_nop 0
    v_add_f32_dpp v238, v238, v238 quad_perm:[2,3,0,1] row_mask:0xf bank_mask:0xf
    v_add_f32_dpp v239, v239, v239 quad_perm:[2,3,0,1] row_mask:0xf bank_mask:0xf
    v_cvt_pk_bf16_f32 v224, v232, v233
    v_lshlrev_b32 v232, 16, v224
    v_and_b32 v233, s39, v224
    v_cvt_pk_bf16_f32 v225, v234, v235
    v_lshlrev_b32 v234, 16, v225
    v_and_b32 v235, s39, v225
    v_cvt_pk_bf16_f32 v226, v236, v237
    v_lshlrev_b32 v236, 16, v226
    v_and_b32 v237, s39, v226
    v_cvt_pk_bf16_f32 v227, v238, v239
    v_lshlrev_b32 v238, 16, v227
    v_and_b32 v239, s39, v227
    v_mul_f32 v232, s70, v232
    v_mul_f32 v233, s70, v233
    v_mul_f32 v234, s70, v234
    v_mul_f32 v235, s70, v235
    v_mul_f32 v236, s70, v236
    v_mul_f32 v237, s70, v237
    v_mul_f32 v238, s70, v238
    v_mul_f32 v239, s70, v239
    v_cvt_pk_bf16_f32 v224, v232, v233
    v_lshlrev_b32 v232, 16, v224
    v_and_b32 v233, s39, v224
    v_cvt_pk_bf16_f32 v225, v234, v235
    v_lshlrev_b32 v234, 16, v225
    v_and_b32 v235, s39, v225
    v_cvt_pk_bf16_f32 v226, v236, v237
    v_lshlrev_b32 v236, 16, v226
    v_and_b32 v237, s39, v226
    v_cvt_pk_bf16_f32 v227, v238, v239
    v_lshlrev_b32 v238, 16, v227
    v_and_b32 v239, s39, v227
    v_max3_f32 v240, v232, v233, v234
    v_max3_f32 v241, v235, v236, v237
    v_max3_f32 v240, v240, v238, v239
    v_max_f32 v240, v240, v241
    s_nop 1
    v_max_f32_dpp v240, v240, v240 row_ror:4 row_mask:0xf bank_mask:0xf
    s_nop 1
    v_max_f32_dpp v240, v240, v240 row_ror:8 row_mask:0xf bank_mask:0xf
    v_mov_b32 v241, v240
    s_nop 1
    v_permlane16_swap_b32 v240, v241
    v_max_f32 v240, v240, v241
    v_mov_b32 v241, v240
    s_nop 1
    v_permlane32_swap_b32 v240, v241
    v_max_f32 v240, v240, v241
    v_mul_f32 v242, s69, v240
    v_fma_f32 v232, v232, s69, -v242
    v_fma_f32 v233, v233, s69, -v242
    v_fma_f32 v234, v234, s69, -v242
    v_fma_f32 v235, v235, s69, -v242
    v_fma_f32 v236, v236, s69, -v242
    v_fma_f32 v237, v237, s69, -v242
    v_fma_f32 v238, v238, s69, -v242
    v_fma_f32 v239, v239, s69, -v242
    v_exp_f32 v232, v232
    v_exp_f32 v233, v233
    v_exp_f32 v234, v234
    v_exp_f32 v235, v235
    v_exp_f32 v236, v236
    v_exp_f32 v237, v237
    v_exp_f32 v238, v238
    v_exp_f32 v239, v239
    v_add_f32 v241, v232, v233
    v_add_f32 v241, v241, v234
    v_add_f32 v241, v241, v235
    v_add_f32 v241, v241, v236
    v_add_f32 v241, v241, v237
    v_add_f32 v241, v241, v238
    v_add_f32 v241, v241, v239
    s_nop 1
    v_add_f32_dpp v241, v241, v241 row_ror:4 row_mask:0xf bank_mask:0xf
    s_nop 1
    v_add_f32_dpp v241, v241, v241 row_ror:8 row_mask:0xf bank_mask:0xf
    v_mov_b32 v242, v241
    s_nop 1
    v_permlane16_swap_b32 v241, v242
    v_add_f32 v241, v241, v242
    v_mov_b32 v242, v241
    s_nop 1
    v_permlane32_swap_b32 v241, v242
    v_add_f32 v241, v241, v242
    s_setprio 1
    s_waitcnt vmcnt(12)
    v_lshlrev_b32 v244, 16, v16
    v_and_b32 v245, s39, v16
    v_lshlrev_b32 v246, 16, v17
    v_and_b32 v247, s39, v17
    v_lshlrev_b32 v248, 16, v18
    v_and_b32 v249, s39, v18
    v_lshlrev_b32 v250, 16, v19
    v_and_b32 v251, s39, v19
    v_mul_f32_dpp v8, v232, v244 row_newbcast:0 row_mask:0xf bank_mask:0xf
    v_mul_f32_dpp v9, v232, v245 row_newbcast:0 row_mask:0xf bank_mask:0xf
    v_mul_f32_dpp v10, v232, v246 row_newbcast:0 row_mask:0xf bank_mask:0xf
    v_mul_f32_dpp v11, v232, v247 row_newbcast:0 row_mask:0xf bank_mask:0xf
    v_mul_f32_dpp v12, v232, v248 row_newbcast:0 row_mask:0xf bank_mask:0xf
    v_mul_f32_dpp v13, v232, v249 row_newbcast:0 row_mask:0xf bank_mask:0xf
    v_mul_f32_dpp v14, v232, v250 row_newbcast:0 row_mask:0xf bank_mask:0xf
    v_mul_f32_dpp v15, v232, v251 row_newbcast:0 row_mask:0xf bank_mask:0xf
    v_lshlrev_b32 v224, 16, v20
    v_and_b32 v225, s39, v20
    v_lshlrev_b32 v226, 16, v21
    v_and_b32 v227, s39, v21
    v_lshlrev_b32 v228, 16, v22
    v_and_b32 v229, s39, v22
    v_lshlrev_b32 v230, 16, v23
    v_and_b32 v231, s39, v23
    v_fmac_f32_dpp v8, v233, v224 row_newbcast:0 row_mask:0xf bank_mask:0xf
    v_fmac_f32_dpp v9, v233, v225 row_newbcast:0 row_mask:0xf bank_mask:0xf
    v_fmac_f32_dpp v10, v233, v226 row_newbcast:0 row_mask:0xf bank_mask:0xf
    v_fmac_f32_dpp v11, v233, v227 row_newbcast:0 row_mask:0xf bank_mask:0xf
    v_fmac_f32_dpp v12, v233, v228 row_newbcast:0 row_mask:0xf bank_mask:0xf
    v_fmac_f32_dpp v13, v233, v229 row_newbcast:0 row_mask:0xf bank_mask:0xf
    v_fmac_f32_dpp v14, v233, v230 row_newbcast:0 row_mask:0xf bank_mask:0xf
    v_fmac_f32_dpp v15, v233, v231 row_newbcast:0 row_mask:0xf bank_mask:0xf
    v_lshlrev_b32 v244, 16, v24
    v_and_b32 v245, s39, v24
    v_lshlrev_b32 v246, 16, v25
    v_and_b32 v247, s39, v25
    v_lshlrev_b32 v248, 16, v26
    v_and_b32 v249, s39, v26
    v_lshlrev_b32 v250, 16, v27
    v_and_b32 v251, s39, v27
    v_fmac_f32_dpp v8, v232, v244 row_newbcast:4 row_mask:0xf bank_mask:0xf
    v_fmac_f32_dpp v9, v232, v245 row_newbcast:4 row_mask:0xf bank_mask:0xf
    v_fmac_f32_dpp v10, v232, v246 row_newbcast:4 row_mask:0xf bank_mask:0xf
    v_fmac_f32_dpp v11, v232, v247 row_newbcast:4 row_mask:0xf bank_mask:0xf
    v_fmac_f32_dpp v12, v232, v248 row_newbcast:4 row_mask:0xf bank_mask:0xf
    v_fmac_f32_dpp v13, v232, v249 row_newbcast:4 row_mask:0xf bank_mask:0xf
    v_fmac_f32_dpp v14, v232, v250 row_newbcast:4 row_mask:0xf bank_mask:0xf
    v_fmac_f32_dpp v15, v232, v251 row_newbcast:4 row_mask:0xf bank_mask:0xf
    v_lshlrev_b32 v224, 16, v28
    v_and_b32 v225, s39, v28
    v_lshlrev_b32 v226, 16, v29
    v_and_b32 v227, s39, v29
    v_lshlrev_b32 v228, 16, v30
    v_and_b32 v229, s39, v30
    v_lshlrev_b32 v230, 16, v31
    v_and_b32 v231, s39, v31
    v_fmac_f32_dpp v8, v233, v224 row_newbcast:4 row_mask:0xf bank_mask:0xf
    v_fmac_f32_dpp v9, v233, v225 row_newbcast:4 row_mask:0xf bank_mask:0xf
    v_fmac_f32_dpp v10, v233, v226 row_newbcast:4 row_mask:0xf bank_mask:0xf
    v_fmac_f32_dpp v11, v233, v227 row_newbcast:4 row_mask:0xf bank_mask:0xf
    v_fmac_f32_dpp v12, v233, v228 row_newbcast:4 row_mask:0xf bank_mask:0xf
    v_fmac_f32_dpp v13, v233, v229 row_newbcast:4 row_mask:0xf bank_mask:0xf
    v_fmac_f32_dpp v14, v233, v230 row_newbcast:4 row_mask:0xf bank_mask:0xf
    v_fmac_f32_dpp v15, v233, v231 row_newbcast:4 row_mask:0xf bank_mask:0xf
    s_add_u32 s32, s43, 16384
    s_and_b32 s32, s32, 0x7c00
    buffer_load_dwordx4 v[80:83], v1, s[12:15], s32 offen nt
    s_add_u32 s32, s43, 17408
    s_and_b32 s32, s32, 0x7c00
    buffer_load_dwordx4 v[84:87], v1, s[12:15], s32 offen nt
    s_add_u32 s32, s43, 18432
    s_and_b32 s32, s32, 0x7c00
    buffer_load_dwordx4 v[88:91], v1, s[12:15], s32 offen nt
    s_add_u32 s32, s43, 19456
    s_and_b32 s32, s32, 0x7c00
    buffer_load_dwordx4 v[92:95], v1, s[12:15], s32 offen nt
    s_waitcnt vmcnt(12)
    v_lshlrev_b32 v244, 16, v32
    v_and_b32 v245, s39, v32
    v_lshlrev_b32 v246, 16, v33
    v_and_b32 v247, s39, v33
    v_lshlrev_b32 v248, 16, v34
    v_and_b32 v249, s39, v34
    v_lshlrev_b32 v250, 16, v35
    v_and_b32 v251, s39, v35
    v_fmac_f32_dpp v8, v232, v244 row_newbcast:8 row_mask:0xf bank_mask:0xf
    v_fmac_f32_dpp v9, v232, v245 row_newbcast:8 row_mask:0xf bank_mask:0xf
    v_fmac_f32_dpp v10, v232, v246 row_newbcast:8 row_mask:0xf bank_mask:0xf
    v_fmac_f32_dpp v11, v232, v247 row_newbcast:8 row_mask:0xf bank_mask:0xf
    v_fmac_f32_dpp v12, v232, v248 row_newbcast:8 row_mask:0xf bank_mask:0xf
    v_fmac_f32_dpp v13, v232, v249 row_newbcast:8 row_mask:0xf bank_mask:0xf
    v_fmac_f32_dpp v14, v232, v250 row_newbcast:8 row_mask:0xf bank_mask:0xf
    v_fmac_f32_dpp v15, v232, v251 row_newbcast:8 row_mask:0xf bank_mask:0xf
    v_lshlrev_b32 v224, 16, v36
    v_and_b32 v225, s39, v36
    v_lshlrev_b32 v226, 16, v37
    v_and_b32 v227, s39, v37
    v_lshlrev_b32 v228, 16, v38
    v_and_b32 v229, s39, v38
    v_lshlrev_b32 v230, 16, v39
    v_and_b32 v231, s39, v39
    v_fmac_f32_dpp v8, v233, v224 row_newbcast:8 row_mask:0xf bank_mask:0xf
    v_fmac_f32_dpp v9, v233, v225 row_newbcast:8 row_mask:0xf bank_mask:0xf
    v_fmac_f32_dpp v10, v233, v226 row_newbcast:8 row_mask:0xf bank_mask:0xf
    v_fmac_f32_dpp v11, v233, v227 row_newbcast:8 row_mask:0xf bank_mask:0xf
    v_fmac_f32_dpp v12, v233, v228 row_newbcast:8 row_mask:0xf bank_mask:0xf
    v_fmac_f32_dpp v13, v233, v229 row_newbcast:8 row_mask:0xf bank_mask:0xf
    v_fmac_f32_dpp v14, v233, v230 row_newbcast:8 row_mask:0xf bank_mask:0xf
    v_fmac_f32_dpp v15, v233, v231 row_newbcast:8 row_mask:0xf bank_mask:0xf
    v_lshlrev_b32 v244, 16, v40
    v_and_b32 v245, s39, v40
    v_lshlrev_b32 v246, 16, v41
    v_and_b32 v247, s39, v41
    v_lshlrev_b32 v248, 16, v42
    v_and_b32 v249, s39, v42
    v_lshlrev_b32 v250, 16, v43
    v_and_b32 v251, s39, v43
    v_fmac_f32_dpp v8, v232, v244 row_newbcast:12 row_mask:0xf bank_mask:0xf
    v_fmac_f32_dpp v9, v232, v245 row_newbcast:12 row_mask:0xf bank_mask:0xf
    v_fmac_f32_dpp v10, v232, v246 row_newbcast:12 row_mask:0xf bank_mask:0xf
    v_fmac_f32_dpp v11, v232, v247 row_newbcast:12 row_mask:0xf bank_mask:0xf
    v_fmac_f32_dpp v12, v232, v248 row_newbcast:12 row_mask:0xf bank_mask:0xf
    v_fmac_f32_dpp v13, v232, v249 row_newbcast:12 row_mask:0xf bank_mask:0xf
    v_fmac_f32_dpp v14, v232, v250 row_newbcast:12 row_mask:0xf bank_mask:0xf
    v_fmac_f32_dpp v15, v232, v251 row_newbcast:12 row_mask:0xf bank_mask:0xf
    v_lshlrev_b32 v224, 16, v44
    v_and_b32 v225, s39, v44
    v_lshlrev_b32 v226, 16, v45
    v_and_b32 v227, s39, v45
    v_lshlrev_b32 v228, 16, v46
    v_and_b32 v229, s39, v46
    v_lshlrev_b32 v230, 16, v47
    v_and_b32 v231, s39, v47
    v_fmac_f32_dpp v8, v233, v224 row_newbcast:12 row_mask:0xf bank_mask:0xf
    v_fmac_f32_dpp v9, v233, v225 row_newbcast:12 row_mask:0xf bank_mask:0xf
    v_fmac_f32_dpp v10, v233, v226 row_newbcast:12 row_mask:0xf bank_mask:0xf
    v_fmac_f32_dpp v11, v233, v227 row_newbcast:12 row_mask:0xf bank_mask:0xf
    v_fmac_f32_dpp v12, v233, v228 row_newbcast:12 row_mask:0xf bank_mask:0xf
    v_fmac_f32_dpp v13, v233, v229 row_newbcast:12 row_mask:0xf bank_mask:0xf
    v_fmac_f32_dpp v14, v233, v230 row_newbcast:12 row_mask:0xf bank_mask:0xf
    v_fmac_f32_dpp v15, v233, v231 row_newbcast:12 row_mask:0xf bank_mask:0xf
    s_add_u32 s32, s43, 20480
    s_and_b32 s32, s32, 0x7c00
    buffer_load_dwordx4 v[96:99], v1, s[12:15], s32 offen nt
    s_add_u32 s32, s43, 21504
    s_and_b32 s32, s32, 0x7c00
    buffer_load_dwordx4 v[100:103], v1, s[12:15], s32 offen nt
    s_add_u32 s32, s43, 22528
    s_and_b32 s32, s32, 0x7c00
    buffer_load_dwordx4 v[104:107], v1, s[12:15], s32 offen nt
    s_add_u32 s32, s43, 23552
    s_and_b32 s32, s32, 0x7c00
    buffer_load_dwordx4 v[108:111], v1, s[12:15], s32 offen nt
    s_waitcnt vmcnt(12)
    v_lshlrev_b32 v244, 16, v48
    v_and_b32 v245, s39, v48
    v_lshlrev_b32 v246, 16, v49
    v_and_b32 v247, s39, v49
    v_lshlrev_b32 v248, 16, v50
    v_and_b32 v249, s39, v50
    v_lshlrev_b32 v250, 16, v51
    v_and_b32 v251, s39, v51
    v_fmac_f32_dpp v8, v234, v244 row_newbcast:0 row_mask:0xf bank_mask:0xf
    v_fmac_f32_dpp v9, v234, v245 row_newbcast:0 row_mask:0xf bank_mask:0xf
    v_fmac_f32_dpp v10, v234, v246 row_newbcast:0 row_mask:0xf bank_mask:0xf
    v_fmac_f32_dpp v11, v234, v247 row_newbcast:0 row_mask:0xf bank_mask:0xf
    v_fmac_f32_dpp v12, v234, v248 row_newbcast:0 row_mask:0xf bank_mask:0xf
    v_fmac_f32_dpp v13, v234, v249 row_newbcast:0 row_mask:0xf bank_mask:0xf
    v_fmac_f32_dpp v14, v234, v250 row_newbcast:0 row_mask:0xf bank_mask:0xf
    v_fmac_f32_dpp v15, v234, v251 row_newbcast:0 row_mask:0xf bank_mask:0xf
    v_lshlrev_b32 v224, 16, v52
    v_and_b32 v225, s39, v52
    v_lshlrev_b32 v226, 16, v53
    v_and_b32 v227, s39, v53
    v_lshlrev_b32 v228, 16, v54
    v_and_b32 v229, s39, v54
    v_lshlrev_b32 v230, 16, v55
    v_and_b32 v231, s39, v55
    v_fmac_f32_dpp v8, v235, v224 row_newbcast:0 row_mask:0xf bank_mask:0xf
    v_fmac_f32_dpp v9, v235, v225 row_newbcast:0 row_mask:0xf bank_mask:0xf
    v_fmac_f32_dpp v10, v235, v226 row_newbcast:0 row_mask:0xf bank_mask:0xf
    v_fmac_f32_dpp v11, v235, v227 row_newbcast:0 row_mask:0xf bank_mask:0xf
    v_fmac_f32_dpp v12, v235, v228 row_newbcast:0 row_mask:0xf bank_mask:0xf
    v_fmac_f32_dpp v13, v235, v229 row_newbcast:0 row_mask:0xf bank_mask:0xf
    v_fmac_f32_dpp v14, v235, v230 row_newbcast:0 row_mask:0xf bank_mask:0xf
    v_fmac_f32_dpp v15, v235, v231 row_newbcast:0 row_mask:0xf bank_mask:0xf
    v_lshlrev_b32 v244, 16, v56
    v_and_b32 v245, s39, v56
    v_lshlrev_b32 v246, 16, v57
    v_and_b32 v247, s39, v57
    v_lshlrev_b32 v248, 16, v58
    v_and_b32 v249, s39, v58
    v_lshlrev_b32 v250, 16, v59
    v_and_b32 v251, s39, v59
    v_fmac_f32_dpp v8, v234, v244 row_newbcast:4 row_mask:0xf bank_mask:0xf
    v_fmac_f32_dpp v9, v234, v245 row_newbcast:4 row_mask:0xf bank_mask:0xf
    v_fmac_f32_dpp v10, v234, v246 row_newbcast:4 row_mask:0xf bank_mask:0xf
    v_fmac_f32_dpp v11, v234, v247 row_newbcast:4 row_mask:0xf bank_mask:0xf
    v_fmac_f32_dpp v12, v234, v248 row_newbcast:4 row_mask:0xf bank_mask:0xf
    v_fmac_f32_dpp v13, v234, v249 row_newbcast:4 row_mask:0xf bank_mask:0xf
    v_fmac_f32_dpp v14, v234, v250 row_newbcast:4 row_mask:0xf bank_mask:0xf
    v_fmac_f32_dpp v15, v234, v251 row_newbcast:4 row_mask:0xf bank_mask:0xf
    v_lshlrev_b32 v224, 16, v60
    v_and_b32 v225, s39, v60
    v_lshlrev_b32 v226, 16, v61
    v_and_b32 v227, s39, v61
    v_lshlrev_b32 v228, 16, v62
    v_and_b32 v229, s39, v62
    v_lshlrev_b32 v230, 16, v63
    v_and_b32 v231, s39, v63
    v_fmac_f32_dpp v8, v235, v224 row_newbcast:4 row_mask:0xf bank_mask:0xf
    v_fmac_f32_dpp v9, v235, v225 row_newbcast:4 row_mask:0xf bank_mask:0xf
    v_fmac_f32_dpp v10, v235, v226 row_newbcast:4 row_mask:0xf bank_mask:0xf
    v_fmac_f32_dpp v11, v235, v227 row_newbcast:4 row_mask:0xf bank_mask:0xf
    v_fmac_f32_dpp v12, v235, v228 row_newbcast:4 row_mask:0xf bank_mask:0xf
    v_fmac_f32_dpp v13, v235, v229 row_newbcast:4 row_mask:0xf bank_mask:0xf
    v_fmac_f32_dpp v14, v235, v230 row_newbcast:4 row_mask:0xf bank_mask:0xf
    v_fmac_f32_dpp v15, v235, v231 row_newbcast:4 row_mask:0xf bank_mask:0xf
    s_add_u32 s32, s43, 24576
    s_and_b32 s32, s32, 0x7c00
    buffer_load_dwordx4 v[112:115], v1, s[12:15], s32 offen nt
    s_add_u32 s32, s43, 25600
    s_and_b32 s32, s32, 0x7c00
    buffer_load_dwordx4 v[116:119], v1, s[12:15], s32 offen nt
    s_add_u32 s32, s43, 26624
    s_and_b32 s32, s32, 0x7c00
    buffer_load_dwordx4 v[120:123], v1, s[12:15], s32 offen nt
    s_add_u32 s32, s43, 27648
    s_and_b32 s32, s32, 0x7c00
    buffer_load_dwordx4 v[124:127], v1, s[12:15], s32 offen nt
    s_waitcnt vmcnt(12)
    v_lshlrev_b32 v244, 16, v64
    v_and_b32 v245, s39, v64
    v_lshlrev_b32 v246, 16, v65
    v_and_b32 v247, s39, v65
    v_lshlrev_b32 v248, 16, v66
    v_and_b32 v249, s39, v66
    v_lshlrev_b32 v250, 16, v67
    v_and_b32 v251, s39, v67
    v_fmac_f32_dpp v8, v234, v244 row_newbcast:8 row_mask:0xf bank_mask:0xf
    v_fmac_f32_dpp v9, v234, v245 row_newbcast:8 row_mask:0xf bank_mask:0xf
    v_fmac_f32_dpp v10, v234, v246 row_newbcast:8 row_mask:0xf bank_mask:0xf
    v_fmac_f32_dpp v11, v234, v247 row_newbcast:8 row_mask:0xf bank_mask:0xf
    v_fmac_f32_dpp v12, v234, v248 row_newbcast:8 row_mask:0xf bank_mask:0xf
    v_fmac_f32_dpp v13, v234, v249 row_newbcast:8 row_mask:0xf bank_mask:0xf
    v_fmac_f32_dpp v14, v234, v250 row_newbcast:8 row_mask:0xf bank_mask:0xf
    v_fmac_f32_dpp v15, v234, v251 row_newbcast:8 row_mask:0xf bank_mask:0xf
    v_lshlrev_b32 v224, 16, v68
    v_and_b32 v225, s39, v68
    v_lshlrev_b32 v226, 16, v69
    v_and_b32 v227, s39, v69
    v_lshlrev_b32 v228, 16, v70
    v_and_b32 v229, s39, v70
    v_lshlrev_b32 v230, 16, v71
    v_and_b32 v231, s39, v71
    v_fmac_f32_dpp v8, v235, v224 row_newbcast:8 row_mask:0xf bank_mask:0xf
    v_fmac_f32_dpp v9, v235, v225 row_newbcast:8 row_mask:0xf bank_mask:0xf
    v_fmac_f32_dpp v10, v235, v226 row_newbcast:8 row_mask:0xf bank_mask:0xf
    v_fmac_f32_dpp v11, v235, v227 row_newbcast:8 row_mask:0xf bank_mask:0xf
    v_fmac_f32_dpp v12, v235, v228 row_newbcast:8 row_mask:0xf bank_mask:0xf
    v_fmac_f32_dpp v13, v235, v229 row_newbcast:8 row_mask:0xf bank_mask:0xf
    v_fmac_f32_dpp v14, v235, v230 row_newbcast:8 row_mask:0xf bank_mask:0xf
    v_fmac_f32_dpp v15, v235, v231 row_newbcast:8 row_mask:0xf bank_mask:0xf
    v_lshlrev_b32 v244, 16, v72
    v_and_b32 v245, s39, v72
    v_lshlrev_b32 v246, 16, v73
    v_and_b32 v247, s39, v73
    v_lshlrev_b32 v248, 16, v74
    v_and_b32 v249, s39, v74
    v_lshlrev_b32 v250, 16, v75
    v_and_b32 v251, s39, v75
    v_fmac_f32_dpp v8, v234, v244 row_newbcast:12 row_mask:0xf bank_mask:0xf
    v_fmac_f32_dpp v9, v234, v245 row_newbcast:12 row_mask:0xf bank_mask:0xf
    v_fmac_f32_dpp v10, v234, v246 row_newbcast:12 row_mask:0xf bank_mask:0xf
    v_fmac_f32_dpp v11, v234, v247 row_newbcast:12 row_mask:0xf bank_mask:0xf
    v_fmac_f32_dpp v12, v234, v248 row_newbcast:12 row_mask:0xf bank_mask:0xf
    v_fmac_f32_dpp v13, v234, v249 row_newbcast:12 row_mask:0xf bank_mask:0xf
    v_fmac_f32_dpp v14, v234, v250 row_newbcast:12 row_mask:0xf bank_mask:0xf
    v_fmac_f32_dpp v15, v234, v251 row_newbcast:12 row_mask:0xf bank_mask:0xf
    v_lshlrev_b32 v224, 16, v76
    v_and_b32 v225, s39, v76
    v_lshlrev_b32 v226, 16, v77
    v_and_b32 v227, s39, v77
    v_lshlrev_b32 v228, 16, v78
    v_and_b32 v229, s39, v78
    v_lshlrev_b32 v230, 16, v79
    v_and_b32 v231, s39, v79
    v_fmac_f32_dpp v8, v235, v224 row_newbcast:12 row_mask:0xf bank_mask:0xf
    v_fmac_f32_dpp v9, v235, v225 row_newbcast:12 row_mask:0xf bank_mask:0xf
    v_fmac_f32_dpp v10, v235, v226 row_newbcast:12 row_mask:0xf bank_mask:0xf
    v_fmac_f32_dpp v11, v235, v227 row_newbcast:12 row_mask:0xf bank_mask:0xf
    v_fmac_f32_dpp v12, v235, v228 row_newbcast:12 row_mask:0xf bank_mask:0xf
    v_fmac_f32_dpp v13, v235, v229 row_newbcast:12 row_mask:0xf bank_mask:0xf
    v_fmac_f32_dpp v14, v235, v230 row_newbcast:12 row_mask:0xf bank_mask:0xf
    v_fmac_f32_dpp v15, v235, v231 row_newbcast:12 row_mask:0xf bank_mask:0xf
    s_setprio 0
    s_add_u32 s32, s43, 28672
    s_and_b32 s32, s32, 0x7c00
    buffer_load_dwordx4 v[128:131], v1, s[12:15], s32 offen nt
    s_add_u32 s32, s43, 29696
    s_and_b32 s32, s32, 0x7c00
    buffer_load_dwordx4 v[132:135], v1, s[12:15], s32 offen nt
    s_add_u32 s32, s43, 30720
    s_and_b32 s32, s32, 0x7c00
    buffer_load_dwordx4 v[136:139], v1, s[12:15], s32 offen nt
    s_add_u32 s32, s43, 31744
    s_and_b32 s32, s32, 0x7c00
    buffer_load_dwordx4 v[140:143], v1, s[12:15], s32 offen nt
    s_waitcnt vmcnt(12)
    v_lshlrev_b32 v244, 16, v80
    v_and_b32 v245, s39, v80
    v_lshlrev_b32 v246, 16, v81
    v_and_b32 v247, s39, v81
    v_lshlrev_b32 v248, 16, v82
    v_and_b32 v249, s39, v82
    v_lshlrev_b32 v250, 16, v83
    v_and_b32 v251, s39, v83
    v_fmac_f32_dpp v8, v236, v244 row_newbcast:0 row_mask:0xf bank_mask:0xf
    v_fmac_f32_dpp v9, v236, v245 row_newbcast:0 row_mask:0xf bank_mask:0xf
    v_fmac_f32_dpp v10, v236, v246 row_newbcast:0 row_mask:0xf bank_mask:0xf
    v_fmac_f32_dpp v11, v236, v247 row_newbcast:0 row_mask:0xf bank_mask:0xf
    v_fmac_f32_dpp v12, v236, v248 row_newbcast:0 row_mask:0xf bank_mask:0xf
    v_fmac_f32_dpp v13, v236, v249 row_newbcast:0 row_mask:0xf bank_mask:0xf
    v_fmac_f32_dpp v14, v236, v250 row_newbcast:0 row_mask:0xf bank_mask:0xf
    v_fmac_f32_dpp v15, v236, v251 row_newbcast:0 row_mask:0xf bank_mask:0xf
    v_lshlrev_b32 v224, 16, v84
    v_and_b32 v225, s39, v84
    v_lshlrev_b32 v226, 16, v85
    v_and_b32 v227, s39, v85
    v_lshlrev_b32 v228, 16, v86
    v_and_b32 v229, s39, v86
    v_lshlrev_b32 v230, 16, v87
    v_and_b32 v231, s39, v87
    v_fmac_f32_dpp v8, v237, v224 row_newbcast:0 row_mask:0xf bank_mask:0xf
    v_fmac_f32_dpp v9, v237, v225 row_newbcast:0 row_mask:0xf bank_mask:0xf
    v_fmac_f32_dpp v10, v237, v226 row_newbcast:0 row_mask:0xf bank_mask:0xf
    v_fmac_f32_dpp v11, v237, v227 row_newbcast:0 row_mask:0xf bank_mask:0xf
    v_fmac_f32_dpp v12, v237, v228 row_newbcast:0 row_mask:0xf bank_mask:0xf
    v_fmac_f32_dpp v13, v237, v229 row_newbcast:0 row_mask:0xf bank_mask:0xf
    v_fmac_f32_dpp v14, v237, v230 row_newbcast:0 row_mask:0xf bank_mask:0xf
    v_fmac_f32_dpp v15, v237, v231 row_newbcast:0 row_mask:0xf bank_mask:0xf
    v_lshlrev_b32 v244, 16, v88
    v_and_b32 v245, s39, v88
    v_lshlrev_b32 v246, 16, v89
    v_and_b32 v247, s39, v89
    v_lshlrev_b32 v248, 16, v90
    v_and_b32 v249, s39, v90
    v_lshlrev_b32 v250, 16, v91
    v_and_b32 v251, s39, v91
    v_fmac_f32_dpp v8, v236, v244 row_newbcast:4 row_mask:0xf bank_mask:0xf
    v_fmac_f32_dpp v9, v236, v245 row_newbcast:4 row_mask:0xf bank_mask:0xf
    v_fmac_f32_dpp v10, v236, v246 row_newbcast:4 row_mask:0xf bank_mask:0xf
    v_fmac_f32_dpp v11, v236, v247 row_newbcast:4 row_mask:0xf bank_mask:0xf
    v_fmac_f32_dpp v12, v236, v248 row_newbcast:4 row_mask:0xf bank_mask:0xf
    v_fmac_f32_dpp v13, v236, v249 row_newbcast:4 row_mask:0xf bank_mask:0xf
    v_fmac_f32_dpp v14, v236, v250 row_newbcast:4 row_mask:0xf bank_mask:0xf
    v_fmac_f32_dpp v15, v236, v251 row_newbcast:4 row_mask:0xf bank_mask:0xf
    v_lshlrev_b32 v224, 16, v92
    v_and_b32 v225, s39, v92
    v_lshlrev_b32 v226, 16, v93
    v_and_b32 v227, s39, v93
    v_lshlrev_b32 v228, 16, v94
    v_and_b32 v229, s39, v94
    v_lshlrev_b32 v230, 16, v95
    v_and_b32 v231, s39, v95
    v_fmac_f32_dpp v8, v237, v224 row_newbcast:4 row_mask:0xf bank_mask:0xf
    v_fmac_f32_dpp v9, v237, v225 row_newbcast:4 row_mask:0xf bank_mask:0xf
    v_fmac_f32_dpp v10, v237, v226 row_newbcast:4 row_mask:0xf bank_mask:0xf
    v_fmac_f32_dpp v11, v237, v227 row_newbcast:4 row_mask:0xf bank_mask:0xf
    v_fmac_f32_dpp v12, v237, v228 row_newbcast:4 row_mask:0xf bank_mask:0xf
    v_fmac_f32_dpp v13, v237, v229 row_newbcast:4 row_mask:0xf bank_mask:0xf
    v_fmac_f32_dpp v14, v237, v230 row_newbcast:4 row_mask:0xf bank_mask:0xf
    v_fmac_f32_dpp v15, v237, v231 row_newbcast:4 row_mask:0xf bank_mask:0xf
    s_cmp_ge_u32 s2, 160
    s_cbranch_scc1 ti_1
    s_and_b32 s40, s2, 7
    s_lshr_b32 s41, s2, 3
    s_and_b32 s42, s41, 3
    s_lshr_b32 s41, s41, 2
    s_lshl_b32 s41, s41, 3
    s_add_u32 s41, s41, s40
    s_mul_i32 s67, s41, 205
    s_lshr_b32 s67, s67, 11
    s_mul_i32 s40, s67, 10
    s_sub_u32 s41, s41, s40
    s_lshl_b32 s41, s41, 2
    s_add_u32 s66, s41, s42
    s_lshl_b32 s40, s67, 3
    s_add_u32 s40, s40, s3
    s_lshl_b32 s40, s40, 7
    v_lshrrev_b32 v3, 1, v0
    v_lshl_add_u32 v3, v3, 2, s40
    v_mul_u32_u24 v3, 1280, v3
    v_and_b32 v2, 1, v0
    v_lshl_add_u32 v3, v2, 4, v3
    s_lshl_b32 s40, s66, 5
    v_add_u32 v3, s40, v3
    s_mov_b32 s24, s52
    s_mov_b32 s25, s53
    s_mov_b32 s26, 5242880
    s_mov_b32 s27, 0x00020000
    buffer_load_dwordx4 v[144:147], v3, s[24:27], 0 offen offset:0
    buffer_load_dwordx4 v[148:151], v3, s[24:27], 0 offen offset:1280
    buffer_load_dwordx4 v[152:155], v3, s[24:27], 0 offen offset:2560
    buffer_load_dwordx4 v[156:159], v3, s[24:27], 0 offen offset:3840
    buffer_load_dwordx4 v[160:163], v3, s[24:27], 0 offen offset:3840
    buffer_load_dwordx4 v[164:167], v3, s[24:27], 0 offen offset:3840
    buffer_load_dwordx4 v[168:171], v3, s[24:27], 0 offen offset:3840
    s_branch ti_3
ti_1:
    s_nop 3
    s_cmp_ge_u32 s2, 216
    s_cbranch_scc1 ti_2
    s_sub_u32 s66, s2, 160
    s_min_u32 s40, s66, 53
    s_lshl_b32 s40, s40, 6
    s_mul_i32 s41, s3, 80
    v_lshrrev_b32 v3, 2, v0
    v_add_u32 v3, s41, v3
    v_mul_u32_u24 v3, 3456, v3
    v_and_b32 v2, 3, v0
    v_lshl_add_u32 v3, v2, 4, v3
    v_add_u32 v3, s40, v3
    s_mov_b32 s24, s56
    s_mov_b32 s25, s57
    s_mov_b32 s26, 2211840
    s_mov_b32 s27, 0x00020000
    s_mov_b32 s32, 0
    buffer_load_dwordx4 v[144:147], v3, s[24:27], s32 offen
    s_mov_b32 s32, 55296
    buffer_load_dwordx4 v[148:151], v3, s[24:27], s32 offen
    s_mov_b32 s32, 110592
    buffer_load_dwordx4 v[152:155], v3, s[24:27], s32 offen
    s_mov_b32 s32, 165888
    buffer_load_dwordx4 v[156:159], v3, s[24:27], s32 offen
    s_mov_b32 s32, 221184
    buffer_load_dwordx4 v[160:163], v3, s[24:27], s32 offen
    s_mov_b32 s32, 221184
    buffer_load_dwordx4 v[164:167], v3, s[24:27], s32 offen
    s_mov_b32 s32, 221184
    buffer_load_dwordx4 v[168:171], v3, s[24:27], s32 offen
    s_branch ti_3
ti_2:
    s_nop 3
    s_sub_u32 s40, s2, 216
    s_and_b32 s41, s40, 7
    s_mul_i32 s41, s41, 5
    s_lshr_b32 s40, s40, 3
    s_add_u32 s66, s41, s40
    s_mul_i32 s41, s3, 224
    v_lshrrev_b32 v3, 1, v0
    v_add_u32 v3, s41, v3
    v_mul_u32_u24 v3, 1280, v3
    v_and_b32 v2, 1, v0
    v_lshl_add_u32 v3, v2, 4, v3
    s_lshl_b32 s40, s66, 5
    v_add_u32 v3, s40, v3
    s_mov_b32 s24, s58
    s_mov_b32 s25, s59
    s_mov_b32 s26, 2211840
    s_mov_b32 s27, 0x00020000
    buffer_load_dwordx4 v[144:147], v3, s[24:27], 0 offen
    v_add_u32 v3, 40960, v3
    buffer_load_dwordx4 v[148:151], v3, s[24:27], 0 offen
    v_add_u32 v3, 40960, v3
    buffer_load_dwordx4 v[152:155], v3, s[24:27], 0 offen
    v_add_u32 v3, 40960, v3
    buffer_load_dwordx4 v[156:159], v3, s[24:27], 0 offen
    v_add_u32 v3, 40960, v3
    buffer_load_dwordx4 v[160:163], v3, s[24:27], 0 offen
    v_add_u32 v3, 40960, v3
    buffer_load_dwordx4 v[164:167], v3, s[24:27], 0 offen
    v_add_u32 v3, 40960, v3
    buffer_load_dwordx4 v[168:171], v3, s[24:27], 0 offen
ti_3:
    s_nop 3
    s_waitcnt vmcnt(15)
    v_lshlrev_b32 v244, 16, v96
    v_and_b32 v245, s39, v96
    v_lshlrev_b32 v246, 16, v97
    v_and_b32 v247, s39, v97
    v_lshlrev_b32 v248, 16, v98
    v_and_b32 v249, s39, v98
    v_lshlrev_b32 v250, 16, v99
    v_and_b32 v251, s39, v99
    v_fmac_f32_dpp v8, v236, v244 row_newbcast:8 row_mask:0xf bank_mask:0xf
    v_fmac_f32_dpp v9, v236, v245 row_newbcast:8 row_mask:0xf bank_mask:0xf
    v_fmac_f32_dpp v10, v236, v246 row_newbcast:8 row_mask:0xf bank_mask:0xf
    v_fmac_f32_dpp v11, v236, v247 row_newbcast:8 row_mask:0xf bank_mask:0xf
    v_fmac_f32_dpp v12, v236, v248 row_newbcast:8 row_mask:0xf bank_mask:0xf
    v_fmac_f32_dpp v13, v236, v249 row_newbcast:8 row_mask:0xf bank_mask:0xf
    v_fmac_f32_dpp v14, v236, v250 row_newbcast:8 row_mask:0xf bank_mask:0xf
    v_fmac_f32_dpp v15, v236, v251 row_newbcast:8 row_mask:0xf bank_mask:0xf
    v_lshlrev_b32 v224, 16, v100
    v_and_b32 v225, s39, v100
    v_lshlrev_b32 v226, 16, v101
    v_and_b32 v227, s39, v101
    v_lshlrev_b32 v228, 16, v102
    v_and_b32 v229, s39, v102
    v_lshlrev_b32 v230, 16, v103
    v_and_b32 v231, s39, v103
    v_fmac_f32_dpp v8, v237, v224 row_newbcast:8 row_mask:0xf bank_mask:0xf
    v_fmac_f32_dpp v9, v237, v225 row_newbcast:8 row_mask:0xf bank_mask:0xf
    v_fmac_f32_dpp v10, v237, v226 row_newbcast:8 row_mask:0xf bank_mask:0xf
    v_fmac_f32_dpp v11, v237, v227 row_newbcast:8 row_mask:0xf bank_mask:0xf
    v_fmac_f32_dpp v12, v237, v228 row_newbcast:8 row_mask:0xf bank_mask:0xf
    v_fmac_f32_dpp v13, v237, v229 row_newbcast:8 row_mask:0xf bank_mask:0xf
    v_fmac_f32_dpp v14, v237, v230 row_newbcast:8 row_mask:0xf bank_mask:0xf
    v_fmac_f32_dpp v15, v237, v231 row_newbcast:8 row_mask:0xf bank_mask:0xf
    v_lshlrev_b32 v244, 16, v104
    v_and_b32 v245, s39, v104
    v_lshlrev_b32 v246, 16, v105
    v_and_b32 v247, s39, v105
    v_lshlrev_b32 v248, 16, v106
    v_and_b32 v249, s39, v106
    v_lshlrev_b32 v250, 16, v107
    v_and_b32 v251, s39, v107
    v_fmac_f32_dpp v8, v236, v244 row_newbcast:12 row_mask:0xf bank_mask:0xf
    v_fmac_f32_dpp v9, v236, v245 row_newbcast:12 row_mask:0xf bank_mask:0xf
    v_fmac_f32_dpp v10, v236, v246 row_newbcast:12 row_mask:0xf bank_mask:0xf
    v_fmac_f32_dpp v11, v236, v247 row_newbcast:12 row_mask:0xf bank_mask:0xf
    v_fmac_f32_dpp v12, v236, v248 row_newbcast:12 row_mask:0xf bank_mask:0xf
    v_fmac_f32_dpp v13, v236, v249 row_newbcast:12 row_mask:0xf bank_mask:0xf
    v_fmac_f32_dpp v14, v236, v250 row_newbcast:12 row_mask:0xf bank_mask:0xf
    v_fmac_f32_dpp v15, v236, v251 row_newbcast:12 row_mask:0xf bank_mask:0xf
    v_lshlrev_b32 v224, 16, v108
    v_and_b32 v225, s39, v108
    v_lshlrev_b32 v226, 16, v109
    v_and_b32 v227, s39, v109
    v_lshlrev_b32 v228, 16, v110
    v_and_b32 v229, s39, v110
    v_lshlrev_b32 v230, 16, v111
    v_and_b32 v231, s39, v111
    v_fmac_f32_dpp v8, v237, v224 row_newbcast:12 row_mask:0xf bank_mask:0xf
    v_fmac_f32_dpp v9, v237, v225 row_newbcast:12 row_mask:0xf bank_mask:0xf
    v_fmac_f32_dpp v10, v237, v226 row_newbcast:12 row_mask:0xf bank_mask:0xf
    v_fmac_f32_dpp v11, v237, v227 row_newbcast:12 row_mask:0xf bank_mask:0xf
    v_fmac_f32_dpp v12, v237, v228 row_newbcast:12 row_mask:0xf bank_mask:0xf
    v_fmac_f32_dpp v13, v237, v229 row_newbcast:12 row_mask:0xf bank_mask:0xf
    v_fmac_f32_dpp v14, v237, v230 row_newbcast:12 row_mask:0xf bank_mask:0xf
    v_fmac_f32_dpp v15, v237, v231 row_newbcast:12 row_mask:0xf bank_mask:0xf
    s_waitcnt vmcnt(11)
    v_lshlrev_b32 v244, 16, v112
    v_and_b32 v245, s39, v112
    v_lshlrev_b32 v246, 16, v113
    v_and_b32 v247, s39, v113
    v_lshlrev_b32 v248, 16, v114
    v_and_b32 v249, s39, v114
    v_lshlrev_b32 v250, 16, v115
    v_and_b32 v251, s39, v115
    v_fmac_f32_dpp v8, v238, v244 row_newbcast:0 row_mask:0xf bank_mask:0xf
    v_fmac_f32_dpp v9, v238, v245 row_newbcast:0 row_mask:0xf bank_mask:0xf
    v_fmac_f32_dpp v10, v238, v246 row_newbcast:0 row_mask:0xf bank_mask:0xf
    v_fmac_f32_dpp v11, v238, v247 row_newbcast:0 row_mask:0xf bank_mask:0xf
    v_fmac_f32_dpp v12, v238, v248 row_newbcast:0 row_mask:0xf bank_mask:0xf
    v_fmac_f32_dpp v13, v238, v249 row_newbcast:0 row_mask:0xf bank_mask:0xf
    v_fmac_f32_dpp v14, v238, v250 row_newbcast:0 row_mask:0xf bank_mask:0xf
    v_fmac_f32_dpp v15, v238, v251 row_newbcast:0 row_mask:0xf bank_mask:0xf
    v_lshlrev_b32 v224, 16, v116
    v_and_b32 v225, s39, v116
    v_lshlrev_b32 v226, 16, v117
    v_and_b32 v227, s39, v117
    v_lshlrev_b32 v228, 16, v118
    v_and_b32 v229, s39, v118
    v_lshlrev_b32 v230, 16, v119
    v_and_b32 v231, s39, v119
    v_fmac_f32_dpp v8, v239, v224 row_newbcast:0 row_mask:0xf bank_mask:0xf
    v_fmac_f32_dpp v9, v239, v225 row_newbcast:0 row_mask:0xf bank_mask:0xf
    v_fmac_f32_dpp v10, v239, v226 row_newbcast:0 row_mask:0xf bank_mask:0xf
    v_fmac_f32_dpp v11, v239, v227 row_newbcast:0 row_mask:0xf bank_mask:0xf
    v_fmac_f32_dpp v12, v239, v228 row_newbcast:0 row_mask:0xf bank_mask:0xf
    v_fmac_f32_dpp v13, v239, v229 row_newbcast:0 row_mask:0xf bank_mask:0xf
    v_fmac_f32_dpp v14, v239, v230 row_newbcast:0 row_mask:0xf bank_mask:0xf
    v_fmac_f32_dpp v15, v239, v231 row_newbcast:0 row_mask:0xf bank_mask:0xf
    v_lshlrev_b32 v244, 16, v120
    v_and_b32 v245, s39, v120
    v_lshlrev_b32 v246, 16, v121
    v_and_b32 v247, s39, v121
    v_lshlrev_b32 v248, 16, v122
    v_and_b32 v249, s39, v122
    v_lshlrev_b32 v250, 16, v123
    v_and_b32 v251, s39, v123
    v_fmac_f32_dpp v8, v238, v244 row_newbcast:4 row_mask:0xf bank_mask:0xf
    v_fmac_f32_dpp v9, v238, v245 row_newbcast:4 row_mask:0xf bank_mask:0xf
    v_fmac_f32_dpp v10, v238, v246 row_newbcast:4 row_mask:0xf bank_mask:0xf
    v_fmac_f32_dpp v11, v238, v247 row_newbcast:4 row_mask:0xf bank_mask:0xf
    v_fmac_f32_dpp v12, v238, v248 row_newbcast:4 row_mask:0xf bank_mask:0xf
    v_fmac_f32_dpp v13, v238, v249 row_newbcast:4 row_mask:0xf bank_mask:0xf
    v_fmac_f32_dpp v14, v238, v250 row_newbcast:4 row_mask:0xf bank_mask:0xf
    v_fmac_f32_dpp v15, v238, v251 row_newbcast:4 row_mask:0xf bank_mask:0xf
    v_lshlrev_b32 v224, 16, v124
    v_and_b32 v225, s39, v124
    v_lshlrev_b32 v226, 16, v125
    v_and_b32 v227, s39, v125
    v_lshlrev_b32 v228, 16, v126
    v_and_b32 v229, s39, v126
    v_lshlrev_b32 v230, 16, v127
    v_and_b32 v231, s39, v127
    v_fmac_f32_dpp v8, v239, v224 row_newbcast:4 row_mask:0xf bank_mask:0xf
    v_fmac_f32_dpp v9, v239, v225 row_newbcast:4 row_mask:0xf bank_mask:0xf
    v_fmac_f32_dpp v10, v239, v226 row_newbcast:4 row_mask:0xf bank_mask:0xf
    v_fmac_f32_dpp v11, v239, v227 row_newbcast:4 row_mask:0xf bank_mask:0xf
    v_fmac_f32_dpp v12, v239, v228 row_newbcast:4 row_mask:0xf bank_mask:0xf
    v_fmac_f32_dpp v13, v239, v229 row_newbcast:4 row_mask:0xf bank_mask:0xf
    v_fmac_f32_dpp v14, v239, v230 row_newbcast:4 row_mask:0xf bank_mask:0xf
    v_fmac_f32_dpp v15, v239, v231 row_newbcast:4 row_mask:0xf bank_mask:0xf
    s_waitcnt vmcnt(7)
    v_lshlrev_b32 v244, 16, v128
    v_and_b32 v245, s39, v128
    v_lshlrev_b32 v246, 16, v129
    v_and_b32 v247, s39, v129
    v_lshlrev_b32 v248, 16, v130
    v_and_b32 v249, s39, v130
    v_lshlrev_b32 v250, 16, v131
    v_and_b32 v251, s39, v131
    v_fmac_f32_dpp v8, v238, v244 row_newbcast:8 row_mask:0xf bank_mask:0xf
    v_fmac_f32_dpp v9, v238, v245 row_newbcast:8 row_mask:0xf bank_mask:0xf
    v_fmac_f32_dpp v10, v238, v246 row_newbcast:8 row_mask:0xf bank_mask:0xf
    v_fmac_f32_dpp v11, v238, v247 row_newbcast:8 row_mask:0xf bank_mask:0xf
    v_fmac_f32_dpp v12, v238, v248 row_newbcast:8 row_mask:0xf bank_mask:0xf
    v_fmac_f32_dpp v13, v238, v249 row_newbcast:8 row_mask:0xf bank_mask:0xf
    v_fmac_f32_dpp v14, v238, v250 row_newbcast:8 row_mask:0xf bank_mask:0xf
    v_fmac_f32_dpp v15, v238, v251 row_newbcast:8 row_mask:0xf bank_mask:0xf
    v_lshlrev_b32 v224, 16, v132
    v_and_b32 v225, s39, v132
    v_lshlrev_b32 v226, 16, v133
    v_and_b32 v227, s39, v133
    v_lshlrev_b32 v228, 16, v134
    v_and_b32 v229, s39, v134
    v_lshlrev_b32 v230, 16, v135
    v_and_b32 v231, s39, v135
    v_fmac_f32_dpp v8, v239, v224 row_newbcast:8 row_mask:0xf bank_mask:0xf
    v_fmac_f32_dpp v9, v239, v225 row_newbcast:8 row_mask:0xf bank_mask:0xf
    v_fmac_f32_dpp v10, v239, v226 row_newbcast:8 row_mask:0xf bank_mask:0xf
    v_fmac_f32_dpp v11, v239, v227 row_newbcast:8 row_mask:0xf bank_mask:0xf
    v_fmac_f32_dpp v12, v239, v228 row_newbcast:8 row_mask:0xf bank_mask:0xf
    v_fmac_f32_dpp v13, v239, v229 row_newbcast:8 row_mask:0xf bank_mask:0xf
    v_fmac_f32_dpp v14, v239, v230 row_newbcast:8 row_mask:0xf bank_mask:0xf
    v_fmac_f32_dpp v15, v239, v231 row_newbcast:8 row_mask:0xf bank_mask:0xf
    v_lshlrev_b32 v244, 16, v136
    v_and_b32 v245, s39, v136
    v_lshlrev_b32 v246, 16, v137
    v_and_b32 v247, s39, v137
    v_lshlrev_b32 v248, 16, v138
    v_and_b32 v249, s39, v138
    v_lshlrev_b32 v250, 16, v139
    v_and_b32 v251, s39, v139
    v_fmac_f32_dpp v8, v238, v244 row_newbcast:12 row_mask:0xf bank_mask:0xf
    v_fmac_f32_dpp v9, v238, v245 row_newbcast:12 row_mask:0xf bank_mask:0xf
    v_fmac_f32_dpp v10, v238, v246 row_newbcast:12 row_mask:0xf bank_mask:0xf
    v_fmac_f32_dpp v11, v238, v247 row_newbcast:12 row_mask:0xf bank_mask:0xf
    v_fmac_f32_dpp v12, v238, v248 row_newbcast:12 row_mask:0xf bank_mask:0xf
    v_fmac_f32_dpp v13, v238, v249 row_newbcast:12 row_mask:0xf bank_mask:0xf
    v_fmac_f32_dpp v14, v238, v250 row_newbcast:12 row_mask:0xf bank_mask:0xf
    v_fmac_f32_dpp v15, v238, v251 row_newbcast:12 row_mask:0xf bank_mask:0xf
    v_lshlrev_b32 v224, 16, v140
    v_and_b32 v225, s39, v140
    v_lshlrev_b32 v226, 16, v141
    v_and_b32 v227, s39, v141
    v_lshlrev_b32 v228, 16, v142
    v_and_b32 v229, s39, v142
    v_lshlrev_b32 v230, 16, v143
    v_and_b32 v231, s39, v143
    v_fmac_f32_dpp v8, v239, v224 row_newbcast:12 row_mask:0xf bank_mask:0xf
    v_fmac_f32_dpp v9, v239, v225 row_newbcast:12 row_mask:0xf bank_mask:0xf
    v_fmac_f32_dpp v10, v239, v226 row_newbcast:12 row_mask:0xf bank_mask:0xf
    v_fmac_f32_dpp v11, v239, v227 row_newbcast:12 row_mask:0xf bank_mask:0xf
    v_fmac_f32_dpp v12, v239, v228 row_newbcast:12 row_mask:0xf bank_mask:0xf
    v_fmac_f32_dpp v13, v239, v229 row_newbcast:12 row_mask:0xf bank_mask:0xf
    v_fmac_f32_dpp v14, v239, v230 row_newbcast:12 row_mask:0xf bank_mask:0xf
    v_fmac_f32_dpp v15, v239, v231 row_newbcast:12 row_mask:0xf bank_mask:0xf
    v_permlane32_swap_b32 v8, v12
    v_permlane32_swap_b32 v9, v13
    v_permlane32_swap_b32 v10, v14
    v_permlane32_swap_b32 v11, v15
    v_add_f32 v8, v8, v12
    v_add_f32 v9, v9, v13
    v_add_f32 v10, v10, v14
    v_add_f32 v11, v11, v15
    s_nop 0
    v_permlane16_swap_b32 v8, v10
    v_permlane16_swap_b32 v9, v11
    v_add_f32 v8, v8, v10
    v_add_f32 v9, v9, v11
    v_lshlrev_b32 v3, 5, v255
    v_lshl_add_u32 v3, v254, 3, v3
    s_lshl_b32 s41, s3, 9
    v_add_u32 v3, s41, v3
    ds_write_b64 v3, v[8:9] offset:24576
    s_lshl_b32 s41, s3, 3
    s_nop 0
    v_mov_b32 v3, s41
    ds_write_b64 v3, v[240:241] offset:28672
    s_waitcnt lgkmcnt(0)
    s_barrier
    s_cmp_lg_u32 s3, 0
    s_cbranch_scc1 PUBDONE
    v_and_b32 v3, 31, v0
    v_lshlrev_b32 v3, 4, v3
    v_mov_b32 v2, 0
    ds_read_b128 v[48:51], v2 offset:28672
    ds_read_b128 v[52:55], v2 offset:28688
    ds_read_b128 v[56:59], v2 offset:28704
    ds_read_b128 v[60:63], v2 offset:28720
    ds_read_b128 v[16:19], v3 offset:24576
    ds_read_b128 v[20:23], v3 offset:25088
    ds_read_b128 v[24:27], v3 offset:25600
    ds_read_b128 v[28:31], v3 offset:26112
    ds_read_b128 v[32:35], v3 offset:26624
    ds_read_b128 v[36:39], v3 offset:27136
    ds_read_b128 v[40:43], v3 offset:27648
    ds_read_b128 v[44:47], v3 offset:28160
    s_lshl_b32 s40, s33, 3
    s_lshl_b32 s41, s34, 2
    s_add_u32 s40, s40, s41
    s_add_u32 s40, s40, s35
    s_lshl_b32 s41, s40, 10
    s_add_u32 s41, s41, 65536
    v_lshl_add_u32 v3, v0, 4, s41
    v_mov_b32 v2, s96
    v_cmp_gt_u32 vcc, 32, v0
    s_waitcnt lgkmcnt(8)
    v_max3_f32 v64, v48, v50, v52
    v_max3_f32 v65, v54, v56, v58
    v_max3_f32 v64, v64, v60, v62
    v_max_f32 v64, v64, v65
    v_sub_f32 v48, v48, v64
    v_sub_f32 v50, v50, v64
    v_sub_f32 v52, v52, v64
    v_sub_f32 v54, v54, v64
    v_sub_f32 v56, v56, v64
    v_sub_f32 v58, v58, v64
    v_sub_f32 v60, v60, v64
    v_sub_f32 v62, v62, v64
    v_mul_f32 v48, s69, v48
    v_mul_f32 v50, s69, v50
    v_mul_f32 v52, s69, v52
    v_mul_f32 v54, s69, v54
    v_mul_f32 v56, s69, v56
    v_mul_f32 v58, s69, v58
    v_mul_f32 v60, s69, v60
    v_mul_f32 v62, s69, v62
    v_exp_f32 v48, v48
    v_exp_f32 v50, v50
    v_exp_f32 v52, v52
    v_exp_f32 v54, v54
    v_exp_f32 v56, v56
    v_exp_f32 v58, v58
    v_exp_f32 v60, v60
    v_exp_f32 v62, v62
    v_mul_f32 v65, v48, v49
    v_fmac_f32 v65, v50, v51
    v_fmac_f32 v65, v52, v53
    v_fmac_f32 v65, v54, v55
    v_fmac_f32 v65, v56, v57
    v_fmac_f32 v65, v58, v59
    v_fmac_f32 v65, v60, v61
    v_fmac_f32 v65, v62, v63
    s_waitcnt lgkmcnt(0)
    v_mul_f32 v66, v48, v16
    v_mul_f32 v67, v48, v17
    v_mul_f32 v68, v48, v18
    v_mul_f32 v69, v48, v19
    v_fmac_f32 v66, v50, v20
    v_fmac_f32 v67, v50, v21
    v_fmac_f32 v68, v50, v22
    v_fmac_f32 v69, v50, v23
    v_fmac_f32 v66, v52, v24
    v_fmac_f32 v67, v52, v25
    v_fmac_f32 v68, v52, v26
    v_fmac_f32 v69, v52, v27
    v_fmac_f32 v66, v54, v28
    v_fmac_f32 v67, v54, v29
    v_fmac_f32 v68, v54, v30
    v_fmac_f32 v69, v54, v31
    v_fmac_f32 v66, v56, v32
    v_fmac_f32 v67, v56, v33
    v_fmac_f32 v68, v56, v34
    v_fmac_f32 v69, v56, v35
    v_fmac_f32 v66, v58, v36
    v_fmac_f32 v67, v58, v37
    v_fmac_f32 v68, v58, v38
    v_fmac_f32 v69, v58, v39
    v_fmac_f32 v66, v60, v40
    v_fmac_f32 v67, v60, v41
    v_fmac_f32 v68, v60, v42
    v_fmac_f32 v69, v60, v43
    v_fmac_f32 v66, v62, v44
    v_fmac_f32 v67, v62, v45
    v_fmac_f32 v68, v62, v46
    v_fmac_f32 v69, v62, v47
    v_cndmask_b32 v66, v64, v66, vcc
    v_cndmask_b32 v67, v65, v67, vcc
    v_cndmask_b32 v68, v64, v68, vcc
    v_cndmask_b32 v69, v65, v69, vcc
    v_and_or_b32 v66, v66, v2, s90
    v_and_or_b32 v67, v67, v2, s91
    v_and_or_b32 v68, v68, v2, s92
    v_and_or_b32 v69, v69, v2, s93
    s_mov_b32 exec_hi, 1
    buffer_store_dwordx4 v[66:69], v3, s[20:23], 0 offen sc1
    s_mov_b32 exec_hi, -1
PUBDONE:
    s_nop 3
    s_cmp_ge_u32 s2, 216
    s_cbranch_scc1 ROLE_F2
    s_cmp_ge_u32 s2, 214
    s_cbranch_scc1 END
    s_cmp_ge_u32 s2, 160
    s_cbranch_scc1 ROLE_F1
    s_lshl_b32 s40, s67, 3
    s_add_u32 s40, s40, s3
    s_lshl_b32 s41, s40, 13
    s_add_u32 s41, s41, 65536
    v_and_b32 v2, 7, v0
    v_lshl_add_u32 v2, v2, 10, s41
    v_lshrrev_b32 v3, 1, v0
    v_lshl_add_u32 v3, v3, 4, s41
    s_movk_i32 s32, 4096
    s_waitcnt vmcnt(0)
    v_lshlrev_b32 v176, 16, v144
    v_and_b32 v177, s39, v144
    v_lshlrev_b32 v178, 16, v145
    v_and_b32 v179, s39, v145
    v_lshlrev_b32 v180, 16, v146
    v_and_b32 v181, s39, v146
    v_lshlrev_b32 v182, 16, v147
    v_and_b32 v183, s39, v147
    v_lshlrev_b32 v184, 16, v148
    v_and_b32 v185, s39, v148
    v_lshlrev_b32 v186, 16, v149
    v_and_b32 v187, s39, v149
    v_lshlrev_b32 v188, 16, v150
    v_and_b32 v189, s39, v150
    v_lshlrev_b32 v190, 16, v151
    v_and_b32 v191, s39, v151
    v_lshlrev_b32 v192, 16, v152
    v_and_b32 v193, s39, v152
    v_lshlrev_b32 v194, 16, v153
    v_and_b32 v195, s39, v153
    v_lshlrev_b32 v196, 16, v154
    v_and_b32 v197, s39, v154
    v_lshlrev_b32 v198, 16, v155
    v_and_b32 v199, s39, v155
    v_lshlrev_b32 v200, 16, v156
    v_and_b32 v201, s39, v156
    v_lshlrev_b32 v202, 16, v157
    v_and_b32 v203, s39, v157
    v_lshlrev_b32 v204, 16, v158
    v_and_b32 v205, s39, v158
    v_lshlrev_b32 v206, 16, v159
    v_and_b32 v207, s39, v159
    s_mov_b32 s68, 0
    s_mov_b32 s97, 0
wl_4:
    s_nop 3
    buffer_load_dwordx4 v[4:7], v2, s[20:23], 0 offen offset:512 sc1
    s_cmp_eq_u32 s97, 0
    s_cbranch_scc1 wn_5
    buffer_load_dwordx4 v[16:19], v3, s[20:23], 0 offen offset:0 sc1
    buffer_load_dwordx4 v[20:23], v3, s[20:23], 0 offen offset:1024 sc1
    buffer_load_dwordx4 v[24:27], v3, s[20:23], 0 offen offset:2048 sc1
    buffer_load_dwordx4 v[28:31], v3, s[20:23], 0 offen offset:3072 sc1
    buffer_load_dwordx4 v[32:35], v3, s[20:23], s32 offen offset:0 sc1
    buffer_load_dwordx4 v[36:39], v3, s[20:23], s32 offen offset:1024 sc1
    buffer_load_dwordx4 v[40:43], v3, s[20:23], s32 offen offset:2048 sc1
    buffer_load_dwordx4 v[44:47], v3, s[20:23], s32 offen offset:3072 sc1
    s_waitcnt vmcnt(8)
    v_xor_b32 v48, s90, v4
    v_xor_b32 v49, s91, v5
    v_bitop3_b32 v48, v48, v6, s92 bitop3:0xf6
    v_bitop3_b32 v49, v49, v7, s93 bitop3:0xf6
    v_or_b32 v48, v48, v49
    v_and_b32 v8, s96, v4
    v_and_b32 v9, s96, v5
    s_nop 0
    v_max_f32_dpp v10, v8, v8 quad_perm:[1,0,3,2] row_mask:0xf bank_mask:0xf
    s_nop 1
    v_max_f32_dpp v10, v10, v10 quad_perm:[2,3,0,1] row_mask:0xf bank_mask:0xf
    v_sub_f32 v11, v8, v10
    v_mul_f32 v11, s69, v11
    v_exp_f32 v11, v11
    s_nop 0
    v_mul_f32 v12, v11, v9
    s_nop 1
    v_add_f32_dpp v12, v12, v12 quad_perm:[1,0,3,2] row_mask:0xf bank_mask:0xf
    s_nop 1
    v_add_f32_dpp v12, v12, v12 quad_perm:[2,3,0,1] row_mask:0xf bank_mask:0xf
    v_rcp_f32 v12, v12
    s_nop 0
    v_mul_f32 v11, v11, v12
    s_waitcnt vmcnt(0)
    v_xor_b32 v49, s90, v16
    v_xor_b32 v50, s91, v17
    v_xor_b32 v51, s92, v18
    v_xor_b32 v52, s93, v19
    v_bitop3_b32 v49, v49, v20, s90 bitop3:0xf6
    v_bitop3_b32 v50, v50, v21, s91 bitop3:0xf6
    v_bitop3_b32 v51, v51, v22, s92 bitop3:0xf6
    v_bitop3_b32 v52, v52, v23, s93 bitop3:0xf6
    v_bitop3_b32 v49, v49, v24, s90 bitop3:0xf6
    v_bitop3_b32 v50, v50, v25, s91 bitop3:0xf6
    v_bitop3_b32 v51, v51, v26, s92 bitop3:0xf6
    v_bitop3_b32 v52, v52, v27, s93 bitop3:0xf6
    v_bitop3_b32 v49, v49, v28, s90 bitop3:0xf6
    v_bitop3_b32 v50, v50, v29, s91 bitop3:0xf6
    v_bitop3_b32 v51, v51, v30, s92 bitop3:0xf6
    v_bitop3_b32 v52, v52, v31, s93 bitop3:0xf6
    v_bitop3_b32 v49, v49, v32, s90 bitop3:0xf6
    v_bitop3_b32 v50, v50, v33, s91 bitop3:0xf6
    v_bitop3_b32 v51, v51, v34, s92 bitop3:0xf6
    v_bitop3_b32 v52, v52, v35, s93 bitop3:0xf6
    v_bitop3_b32 v49, v49, v36, s90 bitop3:0xf6
    v_bitop3_b32 v50, v50, v37, s91 bitop3:0xf6
    v_bitop3_b32 v51, v51, v38, s92 bitop3:0xf6
    v_bitop3_b32 v52, v52, v39, s93 bitop3:0xf6
    v_bitop3_b32 v49, v49, v40, s90 bitop3:0xf6
    v_bitop3_b32 v50, v50, v41, s91 bitop3:0xf6
    v_bitop3_b32 v51, v51, v42, s92 bitop3:0xf6
    v_bitop3_b32 v52, v52, v43, s93 bitop3:0xf6
    v_bitop3_b32 v49, v49, v44, s90 bitop3:0xf6
    v_bitop3_b32 v50, v50, v45, s91 bitop3:0xf6
    v_bitop3_b32 v51, v51, v46, s92 bitop3:0xf6
    v_bitop3_b32 v52, v52, v47, s93 bitop3:0xf6
    v_or_b32 v49, v49, v50
    v_or3_b32 v48, v48, v51, v52
    v_or_b32 v48, v48, v49
    v_and_b32 v48, 0xff, v48
    v_cmp_eq_u32 vcc, 0, v48
    s_nop 1
    s_cmp_eq_u64 vcc, -1
    s_cbranch_scc1 we_6
    s_branch wc_7
wn_5:
    s_nop 3
    s_waitcnt vmcnt(0)
    v_xor_b32 v48, s90, v4
    v_xor_b32 v49, s91, v5
    v_bitop3_b32 v48, v48, v6, s92 bitop3:0xf6
    v_bitop3_b32 v49, v49, v7, s93 bitop3:0xf6
    v_or_b32 v48, v48, v49
    v_and_b32 v48, 0xff, v48
    v_cmp_eq_u32 vcc, 0, v48
    s_nop 1
    s_and_b32 s40, vcc_lo, 0xff
    s_bcnt1_i32_b32 s40, s40
    s_cmp_ge_u32 s40, 7
    s_cselect_b32 s97, 1, 0
    s_cmp_eq_u32 s40, 8
    s_cbranch_scc1 wl_4
wc_7:
    s_nop 3
    s_add_u32 s68, s68, 1
    s_cmp_gt_u32 s68, 40000
    s_cbranch_scc1 we_6
    s_branch wl_4
we_6:
    s_nop 3
    v_and_b32 v16, s96, v16
    v_and_b32 v17, s96, v17
    v_and_b32 v18, s96, v18
    v_and_b32 v19, s96, v19
    v_and_b32 v20, s96, v20
    v_and_b32 v21, s96, v21
    v_and_b32 v22, s96, v22
    v_and_b32 v23, s96, v23
    v_and_b32 v24, s96, v24
    v_and_b32 v25, s96, v25
    v_and_b32 v26, s96, v26
    v_and_b32 v27, s96, v27
    v_and_b32 v28, s96, v28
    v_and_b32 v29, s96, v29
    v_and_b32 v30, s96, v30
    v_and_b32 v31, s96, v31
    v_and_b32 v32, s96, v32
    v_and_b32 v33, s96, v33
    v_and_b32 v34, s96, v34
    v_and_b32 v35, s96, v35
    v_and_b32 v36, s96, v36
    v_and_b32 v37, s96, v37
    v_and_b32 v38, s96, v38
    v_and_b32 v39, s96, v39
    v_and_b32 v40, s96, v40
    v_and_b32 v41, s96, v41
    v_and_b32 v42, s96, v42
    v_and_b32 v43, s96, v43
    v_and_b32 v44, s96, v44
    v_and_b32 v45, s96, v45
    v_and_b32 v46, s96, v46
    v_and_b32 v47, s96, v47
    v_mul_f32_dpp v84, v11, v16 row_newbcast:0 row_mask:0xf bank_mask:0xf
    v_mul_f32_dpp v85, v11, v17 row_newbcast:0 row_mask:0xf bank_mask:0xf
    v_mul_f32_dpp v86, v11, v18 row_newbcast:0 row_mask:0xf bank_mask:0xf
    v_mul_f32_dpp v87, v11, v19 row_newbcast:0 row_mask:0xf bank_mask:0xf
    v_mul_f32_dpp v88, v11, v32 row_newbcast:4 row_mask:0xf bank_mask:0xf
    v_mul_f32_dpp v89, v11, v33 row_newbcast:4 row_mask:0xf bank_mask:0xf
    v_mul_f32_dpp v90, v11, v34 row_newbcast:4 row_mask:0xf bank_mask:0xf
    v_mul_f32_dpp v91, v11, v35 row_newbcast:4 row_mask:0xf bank_mask:0xf
    v_fmac_f32_dpp v84, v11, v20 row_newbcast:1 row_mask:0xf bank_mask:0xf
    v_fmac_f32_dpp v85, v11, v21 row_newbcast:1 row_mask:0xf bank_mask:0xf
    v_fmac_f32_dpp v86, v11, v22 row_newbcast:1 row_mask:0xf bank_mask:0xf
    v_fmac_f32_dpp v87, v11, v23 row_newbcast:1 row_mask:0xf bank_mask:0xf
    v_fmac_f32_dpp v88, v11, v36 row_newbcast:5 row_mask:0xf bank_mask:0xf
    v_fmac_f32_dpp v89, v11, v37 row_newbcast:5 row_mask:0xf bank_mask:0xf
    v_fmac_f32_dpp v90, v11, v38 row_newbcast:5 row_mask:0xf bank_mask:0xf
    v_fmac_f32_dpp v91, v11, v39 row_newbcast:5 row_mask:0xf bank_mask:0xf
    v_fmac_f32_dpp v84, v11, v24 row_newbcast:2 row_mask:0xf bank_mask:0xf
    v_fmac_f32_dpp v85, v11, v25 row_newbcast:2 row_mask:0xf bank_mask:0xf
    v_fmac_f32_dpp v86, v11, v26 row_newbcast:2 row_mask:0xf bank_mask:0xf
    v_fmac_f32_dpp v87, v11, v27 row_newbcast:2 row_mask:0xf bank_mask:0xf
    v_fmac_f32_dpp v88, v11, v40 row_newbcast:6 row_mask:0xf bank_mask:0xf
    v_fmac_f32_dpp v89, v11, v41 row_newbcast:6 row_mask:0xf bank_mask:0xf
    v_fmac_f32_dpp v90, v11, v42 row_newbcast:6 row_mask:0xf bank_mask:0xf
    v_fmac_f32_dpp v91, v11, v43 row_newbcast:6 row_mask:0xf bank_mask:0xf
    v_fmac_f32_dpp v84, v11, v28 row_newbcast:3 row_mask:0xf bank_mask:0xf
    v_fmac_f32_dpp v85, v11, v29 row_newbcast:3 row_mask:0xf bank_mask:0xf
    v_fmac_f32_dpp v86, v11, v30 row_newbcast:3 row_mask:0xf bank_mask:0xf
    v_fmac_f32_dpp v87, v11, v31 row_newbcast:3 row_mask:0xf bank_mask:0xf
    v_fmac_f32_dpp v88, v11, v44 row_newbcast:7 row_mask:0xf bank_mask:0xf
    v_fmac_f32_dpp v89, v11, v45 row_newbcast:7 row_mask:0xf bank_mask:0xf
    v_fmac_f32_dpp v90, v11, v46 row_newbcast:7 row_mask:0xf bank_mask:0xf
    v_fmac_f32_dpp v91, v11, v47 row_newbcast:7 row_mask:0xf bank_mask:0xf
    v_cvt_pk_bf16_f32 v92, v84, v85
    v_lshlrev_b32 v84, 16, v92
    v_and_b32 v85, s39, v92
    v_cvt_pk_bf16_f32 v92, v86, v87
    v_lshlrev_b32 v86, 16, v92
    v_and_b32 v87, s39, v92
    v_cvt_pk_bf16_f32 v92, v88, v89
    v_lshlrev_b32 v88, 16, v92
    v_and_b32 v89, s39, v92
    v_cvt_pk_bf16_f32 v92, v90, v91
    v_lshlrev_b32 v90, 16, v92
    v_and_b32 v91, s39, v92
    v_pk_mul_f32 v[64:65], v[84:85], v[176:177] op_sel:[0,0] op_sel_hi:[0,1]
    v_pk_mul_f32 v[72:73], v[88:89], v[176:177] op_sel:[0,0] op_sel_hi:[0,1]
    v_pk_mul_f32 v[66:67], v[84:85], v[178:179] op_sel:[0,0] op_sel_hi:[0,1]
    v_pk_mul_f32 v[74:75], v[88:89], v[178:179] op_sel:[0,0] op_sel_hi:[0,1]
    v_pk_mul_f32 v[68:69], v[84:85], v[180:181] op_sel:[0,0] op_sel_hi:[0,1]
    v_pk_mul_f32 v[76:77], v[88:89], v[180:181] op_sel:[0,0] op_sel_hi:[0,1]
    v_pk_mul_f32 v[70:71], v[84:85], v[182:183] op_sel:[0,0] op_sel_hi:[0,1]
    v_pk_mul_f32 v[78:79], v[88:89], v[182:183] op_sel:[0,0] op_sel_hi:[0,1]
    v_pk_fma_f32 v[64:65], v[84:85], v[184:185], v[64:65] op_sel:[1,0,0] op_sel_hi:[1,1,1]
    v_pk_fma_f32 v[72:73], v[88:89], v[184:185], v[72:73] op_sel:[1,0,0] op_sel_hi:[1,1,1]
    v_pk_fma_f32 v[66:67], v[84:85], v[186:187], v[66:67] op_sel:[1,0,0] op_sel_hi:[1,1,1]
    v_pk_fma_f32 v[74:75], v[88:89], v[186:187], v[74:75] op_sel:[1,0,0] op_sel_hi:[1,1,1]
    v_pk_fma_f32 v[68:69], v[84:85], v[188:189], v[68:69] op_sel:[1,0,0] op_sel_hi:[1,1,1]
    v_pk_fma_f32 v[76:77], v[88:89], v[188:189], v[76:77] op_sel:[1,0,0] op_sel_hi:[1,1,1]
    v_pk_fma_f32 v[70:71], v[84:85], v[190:191], v[70:71] op_sel:[1,0,0] op_sel_hi:[1,1,1]
    v_pk_fma_f32 v[78:79], v[88:89], v[190:191], v[78:79] op_sel:[1,0,0] op_sel_hi:[1,1,1]
    v_pk_fma_f32 v[64:65], v[86:87], v[192:193], v[64:65] op_sel:[0,0,0] op_sel_hi:[0,1,1]
    v_pk_fma_f32 v[72:73], v[90:91], v[192:193], v[72:73] op_sel:[0,0,0] op_sel_hi:[0,1,1]
    v_pk_fma_f32 v[66:67], v[86:87], v[194:195], v[66:67] op_sel:[0,0,0] op_sel_hi:[0,1,1]
    v_pk_fma_f32 v[74:75], v[90:91], v[194:195], v[74:75] op_sel:[0,0,0] op_sel_hi:[0,1,1]
    v_pk_fma_f32 v[68:69], v[86:87], v[196:197], v[68:69] op_sel:[0,0,0] op_sel_hi:[0,1,1]
    v_pk_fma_f32 v[76:77], v[90:91], v[196:197], v[76:77] op_sel:[0,0,0] op_sel_hi:[0,1,1]
    v_pk_fma_f32 v[70:71], v[86:87], v[198:199], v[70:71] op_sel:[0,0,0] op_sel_hi:[0,1,1]
    v_pk_fma_f32 v[78:79], v[90:91], v[198:199], v[78:79] op_sel:[0,0,0] op_sel_hi:[0,1,1]
    v_pk_fma_f32 v[64:65], v[86:87], v[200:201], v[64:65] op_sel:[1,0,0] op_sel_hi:[1,1,1]
    v_pk_fma_f32 v[72:73], v[90:91], v[200:201], v[72:73] op_sel:[1,0,0] op_sel_hi:[1,1,1]
    v_pk_fma_f32 v[66:67], v[86:87], v[202:203], v[66:67] op_sel:[1,0,0] op_sel_hi:[1,1,1]
    v_pk_fma_f32 v[74:75], v[90:91], v[202:203], v[74:75] op_sel:[1,0,0] op_sel_hi:[1,1,1]
    v_pk_fma_f32 v[68:69], v[86:87], v[204:205], v[68:69] op_sel:[1,0,0] op_sel_hi:[1,1,1]
    v_pk_fma_f32 v[76:77], v[90:91], v[204:205], v[76:77] op_sel:[1,0,0] op_sel_hi:[1,1,1]
    v_pk_fma_f32 v[70:71], v[86:87], v[206:207], v[70:71] op_sel:[1,0,0] op_sel_hi:[1,1,1]
    v_pk_fma_f32 v[78:79], v[90:91], v[206:207], v[78:79] op_sel:[1,0,0] op_sel_hi:[1,1,1]
    v_permlane32_swap_b32 v64, v72
    v_permlane32_swap_b32 v65, v73
    v_permlane32_swap_b32 v66, v74
    v_permlane32_swap_b32 v67, v75
    v_permlane32_swap_b32 v68, v76
    v_permlane32_swap_b32 v69, v77
    v_permlane32_swap_b32 v70, v78
    v_permlane32_swap_b32 v71, v79
    v_add_f32 v64, v64, v72
    v_add_f32 v65, v65, v73
    v_add_f32 v66, v66, v74
    v_add_f32 v67, v67, v75
    v_add_f32 v68, v68, v76
    v_add_f32 v69, v69, v77
    v_add_f32 v70, v70, v78
    v_add_f32 v71, v71, v79
    v_permlane16_swap_b32 v64, v68
    v_permlane16_swap_b32 v65, v69
    v_permlane16_swap_b32 v66, v70
    v_permlane16_swap_b32 v67, v71
    v_add_f32 v64, v64, v68
    v_add_f32 v65, v65, v69
    v_add_f32 v66, v66, v70
    v_add_f32 v67, v67, v71
    v_add_f32_dpp v64, v64, v64 row_ror:8 row_mask:0xf bank_mask:0x3
    v_add_f32_dpp v65, v65, v65 row_ror:8 row_mask:0xf bank_mask:0x3
    v_add_f32_dpp v64, v66, v66 row_ror:8 row_mask:0xf bank_mask:0xc
    v_add_f32_dpp v65, v67, v67 row_ror:8 row_mask:0xf bank_mask:0xc
    s_nop 0
    v_add_f32_dpp v64, v64, v64 row_shl:4 row_mask:0xf bank_mask:0x5
    v_add_f32_dpp v64, v65, v65 row_shr:4 row_mask:0xf bank_mask:0xa
    s_nop 1
    v_add_f32_dpp v64, v64, v64 quad_perm:[2,3,0,1] row_mask:0xf bank_mask:0xf
    v_lshrrev_b32 v3, 5, v0
    v_lshlrev_b32 v3, 4, v3
    v_and_b32 v2, 1, v0
    v_lshl_add_u32 v3, v2, 3, v3
    v_bfe_u32 v2, v0, 2, 3
    v_add_u32 v3, v3, v2
    v_lshlrev_b32 v3, 2, v3
    s_lshl_b32 s40, s3, 8
    v_add_u32 v3, s40, v3
    ds_write_b32 v3, v64 offset:29184
    s_waitcnt lgkmcnt(0)
    s_barrier
    s_cmp_lg_u32 s3, 0
    s_cbranch_scc1 END
    v_lshlrev_b32 v3, 2, v0
    ds_read_b32 v80, v3 offset:29184
    ds_read_b32 v81, v3 offset:29440
    ds_read_b32 v82, v3 offset:29696
    ds_read_b32 v83, v3 offset:29952
    ds_read_b32 v84, v3 offset:30208
    ds_read_b32 v85, v3 offset:30464
    ds_read_b32 v86, v3 offset:30720
    ds_read_b32 v87, v3 offset:30976
    s_waitcnt lgkmcnt(0)
    v_add_f32 v80, v80, v84
    v_add_f32 v81, v81, v85
    v_add_f32 v82, v82, v86
    v_add_f32 v83, v83, v87
    v_add_f32 v80, v80, v82
    v_add_f32 v81, v81, v83
    v_add_f32 v80, v80, v81
    s_mul_i32 s40, s67, 5120
    s_lshl_b32 s41, s66, 6
    s_add_u32 s40, s40, s41
    s_add_u32 s40, s40, 327680
    v_lshrrev_b32 v2, 4, v0
    v_mul_u32_u24 v2, 2560, v2
    v_and_b32 v3, 15, v0
    v_lshl_add_u32 v2, v3, 2, v2
    v_add_u32 v2, s40, v2
    v_and_b32 v3, 3, v0
    v_lshlrev_b32 v3, 3, v3
    v_bfe_u32 v3, s36, v3, 8
    v_mov_b32 v4, s96
    v_and_or_b32 v80, v80, v4, v3
    s_mov_b32 exec_hi, 0
    buffer_store_dword v80, v2, s[20:23], 0 offen sc1
    s_branch END
ROLE_F1:
    s_nop 3
    s_and_b32 s40, s3, 3
    s_lshl_b32 s40, s40, 6
    v_add_u32 v2, s40, v0
    s_lshr_b32 s41, s3, 2
    s_mul_i32 s42, s41, 2560
    s_add_u32 s42, s42, 327680
    v_min_u32 v3, 159, v2
    v_lshl_add_u32 v3, v3, 4, s42
    s_mul_i32 s42, s41, 1280
    v_lshl_add_u32 v4, v2, 3, s42
    v_mov_b32 v5, 0x40000000
    v_cmp_gt_u32 vcc, 160, v2
    s_nop 1
    s_mov_b64 s[98:99], vcc
    v_cndmask_b32 v4, v5, v4, vcc
    s_movk_i32 s32, 5120
    s_movk_i32 s33, 10240
    s_movk_i32 s34, 15360
    buffer_load_dwordx2 v[32:33], v4, s[4:7], 0 offen
    s_lshl_b32 s41, s41, 12
    v_lshl_add_u32 v6, v2, 4, s41
    s_waitcnt vmcnt(0)
    v_lshlrev_b32 v176, 16, v144
    v_and_b32 v177, s39, v144
    v_lshlrev_b32 v178, 16, v145
    v_and_b32 v179, s39, v145
    v_lshlrev_b32 v180, 16, v146
    v_and_b32 v181, s39, v146
    v_lshlrev_b32 v182, 16, v147
    v_and_b32 v183, s39, v147
    v_lshlrev_b32 v184, 16, v148
    v_and_b32 v185, s39, v148
    v_lshlrev_b32 v186, 16, v149
    v_and_b32 v187, s39, v149
    v_lshlrev_b32 v188, 16, v150
    v_and_b32 v189, s39, v150
    v_lshlrev_b32 v190, 16, v151
    v_and_b32 v191, s39, v151
    v_lshlrev_b32 v192, 16, v152
    v_and_b32 v193, s39, v152
    v_lshlrev_b32 v194, 16, v153
    v_and_b32 v195, s39, v153
    v_lshlrev_b32 v196, 16, v154
    v_and_b32 v197, s39, v154
    v_lshlrev_b32 v198, 16, v155
    v_and_b32 v199, s39, v155
    v_lshlrev_b32 v200, 16, v156
    v_and_b32 v201, s39, v156
    v_lshlrev_b32 v202, 16, v157
    v_and_b32 v203, s39, v157
    v_lshlrev_b32 v204, 16, v158
    v_and_b32 v205, s39, v158
    v_lshlrev_b32 v206, 16, v159
    v_and_b32 v207, s39, v159
    v_lshlrev_b32 v208, 16, v160
    v_and_b32 v209, s39, v160
    v_lshlrev_b32 v210, 16, v161
    v_and_b32 v211, s39, v161
    v_lshlrev_b32 v212, 16, v162
    v_and_b32 v213, s39, v162
    v_lshlrev_b32 v214, 16, v163
    v_and_b32 v215, s39, v163
    s_mov_b32 s68, 0
poll_8:
    s_nop 3
    buffer_load_dwordx4 v[16:19], v3, s[20:23], 0 offen sc1
    buffer_load_dwordx4 v[20:23], v3, s[20:23], s32 offen sc1
    buffer_load_dwordx4 v[24:27], v3, s[20:23], s33 offen sc1
    buffer_load_dwordx4 v[28:31], v3, s[20:23], s34 offen sc1
    s_waitcnt vmcnt(0)
    v_xor_b32 v48, s90, v16
    v_xor_b32 v49, s91, v17
    v_xor_b32 v50, s92, v18
    v_xor_b32 v51, s93, v19
    v_bitop3_b32 v48, v48, v20, s90 bitop3:0xf6
    v_bitop3_b32 v49, v49, v21, s91 bitop3:0xf6
    v_bitop3_b32 v50, v50, v22, s92 bitop3:0xf6
    v_bitop3_b32 v51, v51, v23, s93 bitop3:0xf6
    v_bitop3_b32 v48, v48, v24, s90 bitop3:0xf6
    v_bitop3_b32 v49, v49, v25, s91 bitop3:0xf6
    v_bitop3_b32 v50, v50, v26, s92 bitop3:0xf6
    v_bitop3_b32 v51, v51, v27, s93 bitop3:0xf6
    v_bitop3_b32 v48, v48, v28, s90 bitop3:0xf6
    v_bitop3_b32 v49, v49, v29, s91 bitop3:0xf6
    v_bitop3_b32 v50, v50, v30, s92 bitop3:0xf6
    v_bitop3_b32 v51, v51, v31, s93 bitop3:0xf6
    v_or_b32 v48, v48, v49
    v_or_b32 v48, v48, v50
    v_or_b32 v48, v48, v51
    v_and_b32 v48, 0xff, v48
    v_cmp_eq_u32 vcc, 0, v48
    s_add_u32 s68, s68, 1
    s_nop 1
    s_cmp_eq_u64 vcc, -1
    s_cbranch_scc1 pe_9
    s_cmp_gt_u32 s68, 40000
    s_cbranch_scc1 pe_9
    s_branch poll_8
pe_9:
    s_nop 3
    v_and_b32 v16, s96, v16
    v_and_b32 v17, s96, v17
    v_and_b32 v18, s96, v18
    v_and_b32 v19, s96, v19
    v_and_b32 v20, s96, v20
    v_and_b32 v21, s96, v21
    v_and_b32 v22, s96, v22
    v_and_b32 v23, s96, v23
    v_and_b32 v24, s96, v24
    v_and_b32 v25, s96, v25
    v_and_b32 v26, s96, v26
    v_and_b32 v27, s96, v27
    v_and_b32 v28, s96, v28
    v_and_b32 v29, s96, v29
    v_and_b32 v30, s96, v30
    v_and_b32 v31, s96, v31
    v_add_f32 v16, v16, v20
    v_add_f32 v24, v24, v28
    v_add_f32 v17, v17, v21
    v_add_f32 v25, v25, v29
    v_add_f32 v18, v18, v22
    v_add_f32 v26, v26, v30
    v_add_f32 v19, v19, v23
    v_add_f32 v27, v27, v31
    v_add_f32 v16, v16, v24
    v_add_f32 v17, v17, v25
    v_add_f32 v18, v18, v26
    v_add_f32 v19, v19, v27
    v_cndmask_b32 v16, 0, v16, s[98:99]
    v_cndmask_b32 v17, 0, v17, s[98:99]
    v_cndmask_b32 v18, 0, v18, s[98:99]
    v_cndmask_b32 v19, 0, v19, s[98:99]
    v_cvt_pk_bf16_f32 v34, v16, v17
    v_lshlrev_b32 v16, 16, v34
    v_and_b32 v17, s39, v34
    v_cvt_pk_bf16_f32 v34, v18, v19
    v_lshlrev_b32 v18, 16, v34
    v_and_b32 v19, s39, v34
    v_lshlrev_b32 v20, 16, v32
    v_and_b32 v21, s39, v32
    v_lshlrev_b32 v22, 16, v33
    v_and_b32 v23, s39, v33
    v_add_f32 v16, v16, v20
    v_add_f32 v17, v17, v21
    v_add_f32 v18, v18, v22
    v_add_f32 v19, v19, v23
    v_cvt_pk_bf16_f32 v34, v16, v17
    v_lshlrev_b32 v16, 16, v34
    v_and_b32 v17, s39, v34
    v_cvt_pk_bf16_f32 v34, v18, v19
    v_lshlrev_b32 v18, 16, v34
    v_and_b32 v19, s39, v34
    ds_write_b128 v6, v[16:19] offset:0
    v_add_f32 v36, v16, v17
    v_mul_f32 v37, v16, v16
    v_fmac_f32 v37, v17, v17
    v_add_f32 v36, v36, v18
    v_fmac_f32 v37, v18, v18
    v_add_f32 v36, v36, v19
    v_fmac_f32 v37, v19, v19
    s_nop 0
    v_add_f32_dpp v36, v36, v36 row_ror:8 row_mask:0xf bank_mask:0xf
    v_add_f32_dpp v37, v37, v37 row_ror:8 row_mask:0xf bank_mask:0xf
    s_nop 0
    v_add_f32_dpp v36, v36, v36 row_ror:4 row_mask:0xf bank_mask:0xf
    v_add_f32_dpp v37, v37, v37 row_ror:4 row_mask:0xf bank_mask:0xf
    s_nop 0
    v_add_f32_dpp v36, v36, v36 row_ror:2 row_mask:0xf bank_mask:0xf
    v_add_f32_dpp v37, v37, v37 row_ror:2 row_mask:0xf bank_mask:0xf
    s_nop 0
    v_add_f32_dpp v36, v36, v36 row_ror:1 row_mask:0xf bank_mask:0xf
    v_add_f32_dpp v37, v37, v37 row_ror:1 row_mask:0xf bank_mask:0xf
    v_mov_b32 v38, v36
    v_mov_b32 v39, v37
    s_nop 0
    v_permlane16_swap_b32 v36, v38
    v_permlane16_swap_b32 v37, v39
    v_add_f32 v36, v36, v38
    v_add_f32 v37, v37, v39
    v_mov_b32 v38, v36
    v_mov_b32 v39, v37
    s_nop 0
    v_permlane32_swap_b32 v36, v38
    v_permlane32_swap_b32 v37, v39
    v_add_f32 v36, v36, v38
    v_add_f32 v37, v37, v39
    s_lshl_b32 s40, s3, 3
    v_mov_b32 v2, s40
    ds_write_b64 v2, v[36:37] offset:31232
    s_waitcnt lgkmcnt(0)
    s_barrier
    v_mov_b32 v2, 0
    ds_read_b128 v[16:19], v2 offset:31232
    ds_read_b128 v[20:23], v2 offset:31248
    ds_read_b128 v[24:27], v2 offset:31264
    ds_read_b128 v[28:31], v2 offset:31280
    s_mul_i32 s40, s3, 80
    v_lshrrev_b32 v3, 2, v0
    v_add_u32 v3, s40, v3
    v_lshlrev_b32 v3, 2, v3
    ds_read_b32 v40, v3 offset:0
    ds_read_b32 v41, v3 offset:64
    ds_read_b32 v42, v3 offset:128
    ds_read_b32 v43, v3 offset:192
    ds_read_b32 v44, v3 offset:256
    ds_read_b32 v45, v3 offset:4096
    ds_read_b32 v46, v3 offset:4160
    ds_read_b32 v47, v3 offset:4224
    ds_read_b32 v48, v3 offset:4288
    ds_read_b32 v49, v3 offset:4352
    s_waitcnt lgkmcnt(0)
    v_add_f32 v16, v16, v18
    v_add_f32 v20, v20, v22
    v_add_f32 v17, v17, v19
    v_add_f32 v21, v21, v23
    v_add_f32 v16, v16, v20
    v_add_f32 v17, v17, v21
    v_mul_f32 v16, s71, v16
    v_mul_f32 v17, s71, v17
    v_fma_f32 v17, -v16, v16, v17
    v_cvt_pk_bf16_f32 v34, v16, v17
    v_lshlrev_b32 v16, 16, v34
    v_and_b32 v17, s39, v34
    v_add_f32 v17, 0x3727c5ac, v17
    v_cvt_pk_bf16_f32 v17, v17, v17
    v_and_b32 v17, s39, v17
    v_sqrt_f32 v17, v17
    s_nop 0
    v_cvt_pk_bf16_f32 v17, v17, v17
    v_and_b32 v17, s39, v17
    v_rcp_f32 v17, v17
    v_add_f32 v24, v24, v26
    v_add_f32 v28, v28, v30
    v_add_f32 v25, v25, v27
    v_add_f32 v29, v29, v31
    v_add_f32 v24, v24, v28
    v_add_f32 v25, v25, v29
    v_mul_f32 v24, s71, v24
    v_mul_f32 v25, s71, v25
    v_fma_f32 v25, -v24, v24, v25
    v_cvt_pk_bf16_f32 v34, v24, v25
    v_lshlrev_b32 v24, 16, v34
    v_and_b32 v25, s39, v34
    v_add_f32 v25, 0x3727c5ac, v25
    v_cvt_pk_bf16_f32 v25, v25, v25
    v_and_b32 v25, s39, v25
    v_sqrt_f32 v25, v25
    s_nop 0
    v_cvt_pk_bf16_f32 v25, v25, v25
    v_and_b32 v25, s39, v25
    v_rcp_f32 v25, v25
    v_sub_f32 v40, v40, v16
    v_sub_f32 v41, v41, v16
    v_sub_f32 v42, v42, v16
    v_sub_f32 v43, v43, v16
    v_sub_f32 v44, v44, v16
    v_sub_f32 v45, v45, v24
    v_sub_f32 v46, v46, v24
    v_sub_f32 v47, v47, v24
    v_sub_f32 v48, v48, v24
    v_sub_f32 v49, v49, v24
    v_cvt_pk_bf16_f32 v34, v40, v41
    v_lshlrev_b32 v40, 16, v34
    v_and_b32 v41, s39, v34
    v_cvt_pk_bf16_f32 v34, v42, v43
    v_lshlrev_b32 v42, 16, v34
    v_and_b32 v43, s39, v34
    v_cvt_pk_bf16_f32 v34, v44, v45
    v_lshlrev_b32 v44, 16, v34
    v_and_b32 v45, s39, v34
    v_cvt_pk_bf16_f32 v34, v46, v47
    v_lshlrev_b32 v46, 16, v34
    v_and_b32 v47, s39, v34
    v_cvt_pk_bf16_f32 v34, v48, v49
    v_lshlrev_b32 v48, 16, v34
    v_and_b32 v49, s39, v34
    v_mul_f32 v40, v40, v17
    v_mul_f32 v41, v41, v17
    v_mul_f32 v42, v42, v17
    v_mul_f32 v43, v43, v17
    v_mul_f32 v44, v44, v17
    v_mul_f32 v45, v45, v25
    v_mul_f32 v46, v46, v25
    v_mul_f32 v47, v47, v25
    v_mul_f32 v48, v48, v25
    v_mul_f32 v49, v49, v25
    v_cvt_pk_bf16_f32 v34, v40, v41
    v_lshlrev_b32 v40, 16, v34
    v_and_b32 v41, s39, v34
    v_cvt_pk_bf16_f32 v34, v42, v43
    v_lshlrev_b32 v42, 16, v34
    v_and_b32 v43, s39, v34
    v_cvt_pk_bf16_f32 v34, v44, v45
    v_lshlrev_b32 v44, 16, v34
    v_and_b32 v45, s39, v34
    v_cvt_pk_bf16_f32 v34, v46, v47
    v_lshlrev_b32 v46, 16, v34
    v_and_b32 v47, s39, v34
    v_cvt_pk_bf16_f32 v34, v48, v49
    v_lshlrev_b32 v48, 16, v34
    v_and_b32 v49, s39, v34
    v_pk_mul_f32 v[64:65], v[40:41], v[176:177] op_sel:[0,0] op_sel_hi:[0,1]
    v_pk_mul_f32 v[72:73], v[44:45], v[176:177] op_sel:[1,0] op_sel_hi:[1,1]
    v_pk_mul_f32 v[66:67], v[40:41], v[178:179] op_sel:[0,0] op_sel_hi:[0,1]
    v_pk_mul_f32 v[74:75], v[44:45], v[178:179] op_sel:[1,0] op_sel_hi:[1,1]
    v_pk_mul_f32 v[68:69], v[40:41], v[180:181] op_sel:[0,0] op_sel_hi:[0,1]
    v_pk_mul_f32 v[76:77], v[44:45], v[180:181] op_sel:[1,0] op_sel_hi:[1,1]
    v_pk_mul_f32 v[70:71], v[40:41], v[182:183] op_sel:[0,0] op_sel_hi:[0,1]
    v_pk_mul_f32 v[78:79], v[44:45], v[182:183] op_sel:[1,0] op_sel_hi:[1,1]
    v_pk_fma_f32 v[64:65], v[40:41], v[184:185], v[64:65] op_sel:[1,0,0] op_sel_hi:[1,1,1]
    v_pk_fma_f32 v[72:73], v[46:47], v[184:185], v[72:73] op_sel:[0,0,0] op_sel_hi:[0,1,1]
    v_pk_fma_f32 v[66:67], v[40:41], v[186:187], v[66:67] op_sel:[1,0,0] op_sel_hi:[1,1,1]
    v_pk_fma_f32 v[74:75], v[46:47], v[186:187], v[74:75] op_sel:[0,0,0] op_sel_hi:[0,1,1]
    v_pk_fma_f32 v[68:69], v[40:41], v[188:189], v[68:69] op_sel:[1,0,0] op_sel_hi:[1,1,1]
    v_pk_fma_f32 v[76:77], v[46:47], v[188:189], v[76:77] op_sel:[0,0,0] op_sel_hi:[0,1,1]
    v_pk_fma_f32 v[70:71], v[40:41], v[190:191], v[70:71] op_sel:[1,0,0] op_sel_hi:[1,1,1]
    v_pk_fma_f32 v[78:79], v[46:47], v[190:191], v[78:79] op_sel:[0,0,0] op_sel_hi:[0,1,1]
    v_pk_fma_f32 v[64:65], v[42:43], v[192:193], v[64:65] op_sel:[0,0,0] op_sel_hi:[0,1,1]
    v_pk_fma_f32 v[72:73], v[46:47], v[192:193], v[72:73] op_sel:[1,0,0] op_sel_hi:[1,1,1]
    v_pk_fma_f32 v[66:67], v[42:43], v[194:195], v[66:67] op_sel:[0,0,0] op_sel_hi:[0,1,1]
    v_pk_fma_f32 v[74:75], v[46:47], v[194:195], v[74:75] op_sel:[1,0,0] op_sel_hi:[1,1,1]
    v_pk_fma_f32 v[68:69], v[42:43], v[196:197], v[68:69] op_sel:[0,0,0] op_sel_hi:[0,1,1]
    v_pk_fma_f32 v[76:77], v[46:47], v[196:197], v[76:77] op_sel:[1,0,0] op_sel_hi:[1,1,1]
    v_pk_fma_f32 v[70:71], v[42:43], v[198:199], v[70:71] op_sel:[0,0,0] op_sel_hi:[0,1,1]
    v_pk_fma_f32 v[78:79], v[46:47], v[198:199], v[78:79] op_sel:[1,0,0] op_sel_hi:[1,1,1]
    v_pk_fma_f32 v[64:65], v[42:43], v[200:201], v[64:65] op_sel:[1,0,0] op_sel_hi:[1,1,1]
    v_pk_fma_f32 v[72:73], v[48:49], v[200:201], v[72:73] op_sel:[0,0,0] op_sel_hi:[0,1,1]
    v_pk_fma_f32 v[66:67], v[42:43], v[202:203], v[66:67] op_sel:[1,0,0] op_sel_hi:[1,1,1]
    v_pk_fma_f32 v[74:75], v[48:49], v[202:203], v[74:75] op_sel:[0,0,0] op_sel_hi:[0,1,1]
    v_pk_fma_f32 v[68:69], v[42:43], v[204:205], v[68:69] op_sel:[1,0,0] op_sel_hi:[1,1,1]
    v_pk_fma_f32 v[76:77], v[48:49], v[204:205], v[76:77] op_sel:[0,0,0] op_sel_hi:[0,1,1]
    v_pk_fma_f32 v[70:71], v[42:43], v[206:207], v[70:71] op_sel:[1,0,0] op_sel_hi:[1,1,1]
    v_pk_fma_f32 v[78:79], v[48:49], v[206:207], v[78:79] op_sel:[0,0,0] op_sel_hi:[0,1,1]
    v_pk_fma_f32 v[64:65], v[44:45], v[208:209], v[64:65] op_sel:[0,0,0] op_sel_hi:[0,1,1]
    v_pk_fma_f32 v[72:73], v[48:49], v[208:209], v[72:73] op_sel:[1,0,0] op_sel_hi:[1,1,1]
    v_pk_fma_f32 v[66:67], v[44:45], v[210:211], v[66:67] op_sel:[0,0,0] op_sel_hi:[0,1,1]
    v_pk_fma_f32 v[74:75], v[48:49], v[210:211], v[74:75] op_sel:[1,0,0] op_sel_hi:[1,1,1]
    v_pk_fma_f32 v[68:69], v[44:45], v[212:213], v[68:69] op_sel:[0,0,0] op_sel_hi:[0,1,1]
    v_pk_fma_f32 v[76:77], v[48:49], v[212:213], v[76:77] op_sel:[1,0,0] op_sel_hi:[1,1,1]
    v_pk_fma_f32 v[70:71], v[44:45], v[214:215], v[70:71] op_sel:[0,0,0] op_sel_hi:[0,1,1]
    v_pk_fma_f32 v[78:79], v[48:49], v[214:215], v[78:79] op_sel:[1,0,0] op_sel_hi:[1,1,1]
    v_permlane32_swap_b32 v64, v72
    v_permlane32_swap_b32 v65, v73
    v_permlane32_swap_b32 v66, v74
    v_permlane32_swap_b32 v67, v75
    v_permlane32_swap_b32 v68, v76
    v_permlane32_swap_b32 v69, v77
    v_permlane32_swap_b32 v70, v78
    v_permlane32_swap_b32 v71, v79
    v_add_f32 v64, v64, v72
    v_add_f32 v65, v65, v73
    v_add_f32 v66, v66, v74
    v_add_f32 v67, v67, v75
    v_add_f32 v68, v68, v76
    v_add_f32 v69, v69, v77
    v_add_f32 v70, v70, v78
    v_add_f32 v71, v71, v79
    v_permlane16_swap_b32 v64, v68
    v_permlane16_swap_b32 v65, v69
    v_permlane16_swap_b32 v66, v70
    v_permlane16_swap_b32 v67, v71
    v_add_f32 v64, v64, v68
    v_add_f32 v65, v65, v69
    v_add_f32 v66, v66, v70
    v_add_f32 v67, v67, v71
    v_add_f32_dpp v64, v64, v64 row_ror:8 row_mask:0xf bank_mask:0x3
    v_add_f32_dpp v65, v65, v65 row_ror:8 row_mask:0xf bank_mask:0x3
    v_add_f32_dpp v64, v66, v66 row_ror:8 row_mask:0xf bank_mask:0xc
    v_add_f32_dpp v65, v67, v67 row_ror:8 row_mask:0xf bank_mask:0xc
    s_nop 0
    v_add_f32_dpp v64, v64, v64 row_shl:4 row_mask:0xf bank_mask:0x5
    v_add_f32_dpp v64, v65, v65 row_shr:4 row_mask:0xf bank_mask:0xa
    v_and_b32 v3, 32, v0
    v_and_b32 v2, 3, v0
    v_lshl_add_u32 v3, v2, 3, v3
    v_bfe_u32 v2, v0, 2, 3
    v_add_u32 v3, v3, v2
    v_lshlrev_b32 v3, 2, v3
    s_lshl_b32 s40, s3, 8
    v_add_u32 v3, s40, v3
    ds_write_b32 v3, v64 offset:29184
    s_waitcnt lgkmcnt(0)
    s_barrier
    s_cmp_lg_u32 s3, 0
    s_cbranch_scc1 END
    v_lshlrev_b32 v3, 2, v0
    ds_read_b32 v80, v3 offset:29184
    ds_read_b32 v81, v3 offset:29440
    ds_read_b32 v82, v3 offset:29696
    ds_read_b32 v83, v3 offset:29952
    ds_read_b32 v84, v3 offset:30208
    ds_read_b32 v85, v3 offset:30464
    ds_read_b32 v86, v3 offset:30720
    ds_read_b32 v87, v3 offset:30976
    s_waitcnt lgkmcnt(0)
    v_add_f32 v80, v80, v84
    v_add_f32 v81, v81, v85
    v_add_f32 v82, v82, v86
    v_add_f32 v83, v83, v87
    v_add_f32 v80, v80, v82
    v_add_f32 v81, v81, v83
    v_add_f32 v80, v80, v81
    v_cvt_pk_bf16_f32 v80, v80, v80
    v_and_b32 v80, s39, v80
    v_max_f32 v80, 0, v80
    s_lshl_b32 s40, s66, 8
    s_add_u32 s40, s40, 360448
    v_and_b32 v2, 31, v0
    v_lshlrev_b32 v2, 3, v2
    v_lshrrev_b32 v3, 5, v0
    v_lshl_add_u32 v2, v3, 2, v2
    v_add_u32 v2, s40, v2
    v_lshlrev_b32 v3, 4, v3
    v_bfe_u32 v3, s36, v3, 16
    v_or_b32 v80, v80, v3
    buffer_store_dword v80, v2, s[20:23], 0 offen sc1
    s_branch END
ROLE_F2:
    s_nop 3
    s_add_u32 s24, s64, 360448
    s_addc_u32 s25, s65, 0
    s_mov_b32 s26, 13824
    s_mov_b32 s27, 0x00020000
    s_mov_b32 s28, s60
    s_mov_b32 s29, s61
    s_mov_b32 s30, 2560
    s_mov_b32 s31, 0x00020000
    v_bfe_u32 v2, v0, 4, 1
    v_and_b32 v3, 15, v0
    s_lshl_b32 s40, s66, 4
    v_add_u32 v3, s40, v3
    v_mul_u32_u24 v4, 640, v2
    v_add_u32 v4, v4, v3
    v_lshlrev_b32 v8, 1, v4
    v_lshlrev_b32 v4, 2, v4
    v_add_u32 v4, 327680, v4
    s_movk_i32 s32, 5120
    s_movk_i32 s33, 10240
    s_movk_i32 s34, 15360
    buffer_load_ushort v14, v8, s[4:7], 0 offen
    v_and_b32 v5, 3, v0
    v_lshlrev_b32 v5, 3, v5
    v_bfe_u32 v5, s36, v5, 8
    s_mul_i32 s40, s3, 224
    v_lshrrev_b32 v3, 1, v0
    v_add_u32 v3, s40, v3
    v_lshlrev_b32 v3, 3, v3
    v_add_u32 v40, 0, v3
    v_min_u32 v40, 13816, v40
    v_add_u32 v41, 256, v3
    v_min_u32 v41, 13816, v41
    v_add_u32 v42, 512, v3
    v_min_u32 v42, 13816, v42
    v_add_u32 v43, 768, v3
    v_min_u32 v43, 13816, v43
    v_add_u32 v44, 1024, v3
    v_min_u32 v44, 13816, v44
    v_add_u32 v45, 1280, v3
    v_min_u32 v45, 13816, v45
    v_add_u32 v46, 1536, v3
    v_min_u32 v46, 13816, v46
    s_lshl_b32 s41, s94, 0
    s_lshl_b32 s42, s95, 0
    s_waitcnt vmcnt(0)
    v_lshlrev_b32 v176, 16, v144
    v_and_b32 v177, s39, v144
    v_lshlrev_b32 v178, 16, v145
    v_and_b32 v179, s39, v145
    v_lshlrev_b32 v180, 16, v146
    v_and_b32 v181, s39, v146
    v_lshlrev_b32 v182, 16, v147
    v_and_b32 v183, s39, v147
    v_lshlrev_b32 v184, 16, v148
    v_and_b32 v185, s39, v148
    v_lshlrev_b32 v186, 16, v149
    v_and_b32 v187, s39, v149
    v_lshlrev_b32 v188, 16, v150
    v_and_b32 v189, s39, v150
    v_lshlrev_b32 v190, 16, v151
    v_and_b32 v191, s39, v151
    v_lshlrev_b32 v192, 16, v152
    v_and_b32 v193, s39, v152
    v_lshlrev_b32 v194, 16, v153
    v_and_b32 v195, s39, v153
    v_lshlrev_b32 v196, 16, v154
    v_and_b32 v197, s39, v154
    v_lshlrev_b32 v198, 16, v155
    v_and_b32 v199, s39, v155
    v_lshlrev_b32 v200, 16, v156
    v_and_b32 v201, s39, v156
    v_lshlrev_b32 v202, 16, v157
    v_and_b32 v203, s39, v157
    v_lshlrev_b32 v204, 16, v158
    v_and_b32 v205, s39, v158
    v_lshlrev_b32 v206, 16, v159
    v_and_b32 v207, s39, v159
    v_lshlrev_b32 v208, 16, v160
    v_and_b32 v209, s39, v160
    v_lshlrev_b32 v210, 16, v161
    v_and_b32 v211, s39, v161
    v_lshlrev_b32 v212, 16, v162
    v_and_b32 v213, s39, v162
    v_lshlrev_b32 v214, 16, v163
    v_and_b32 v215, s39, v163
    v_lshlrev_b32 v216, 16, v164
    v_and_b32 v217, s39, v164
    v_lshlrev_b32 v218, 16, v165
    v_and_b32 v219, s39, v165
    v_lshlrev_b32 v220, 16, v166
    v_and_b32 v221, s39, v166
    v_lshlrev_b32 v222, 16, v167
    v_and_b32 v223, s39, v167
    v_lshlrev_b32 v224, 16, v168
    v_and_b32 v225, s39, v168
    v_lshlrev_b32 v226, 16, v169
    v_and_b32 v227, s39, v169
    v_lshlrev_b32 v228, 16, v170
    v_and_b32 v229, s39, v170
    v_lshlrev_b32 v230, 16, v171
    v_and_b32 v231, s39, v171
    s_mov_b32 s68, 0
poll_11:
    s_nop 3
    buffer_load_dwordx2 v[16:17], v40, s[24:27], 0 offen sc1
    buffer_load_dwordx2 v[18:19], v41, s[24:27], 0 offen sc1
    buffer_load_dwordx2 v[20:21], v42, s[24:27], 0 offen sc1
    buffer_load_dwordx2 v[22:23], v43, s[24:27], 0 offen sc1
    buffer_load_dwordx2 v[24:25], v44, s[24:27], 0 offen sc1
    buffer_load_dwordx2 v[26:27], v45, s[24:27], 0 offen sc1
    buffer_load_dwordx2 v[28:29], v46, s[24:27], 0 offen sc1
    buffer_load_dword v10, v4, s[20:23], 0 offen sc1
    buffer_load_dword v11, v4, s[20:23], s32 offen sc1
    buffer_load_dword v12, v4, s[20:23], s33 offen sc1
    buffer_load_dword v13, v4, s[20:23], s34 offen sc1
    s_waitcnt vmcnt(0)
    v_xor_b32 v48, s94, v16
    v_xor_b32 v49, s95, v17
    v_xor_b32 v50, s94, v18
    v_xor_b32 v51, s95, v19
    v_bitop3_b32 v48, v48, v20, s94 bitop3:0xf6
    v_bitop3_b32 v49, v49, v21, s95 bitop3:0xf6
    v_bitop3_b32 v50, v50, v22, s94 bitop3:0xf6
    v_bitop3_b32 v51, v51, v23, s95 bitop3:0xf6
    v_bitop3_b32 v48, v48, v24, s94 bitop3:0xf6
    v_bitop3_b32 v49, v49, v25, s95 bitop3:0xf6
    v_bitop3_b32 v50, v50, v26, s94 bitop3:0xf6
    v_bitop3_b32 v51, v51, v27, s95 bitop3:0xf6
    v_bitop3_b32 v48, v48, v28, s94 bitop3:0xf6
    v_bitop3_b32 v49, v49, v29, s95 bitop3:0xf6
    v_xor_b32 v52, v5, v10
    v_bitop3_b32 v52, v52, v11, v5 bitop3:0xf6
    v_bitop3_b32 v52, v52, v12, v5 bitop3:0xf6
    v_bitop3_b32 v52, v52, v13, v5 bitop3:0xf6
    v_or_b32 v48, v48, v49
    v_or_b32 v48, v48, v50
    v_or_b32 v48, v48, v51
    v_and_b32 v48, 0xffff, v48
    v_and_b32 v52, 0xff, v52
    v_or_b32 v48, v48, v52
    v_cmp_eq_u32 vcc, 0, v48
    s_add_u32 s68, s68, 1
    s_nop 1
    s_cmp_eq_u64 vcc, -1
    s_cbranch_scc1 pe_12
    s_cmp_gt_u32 s68, 40000
    s_cbranch_scc1 pe_12
    s_branch poll_11
pe_12:
    s_nop 3
    s_cmp_lg_u32 s66, 0
    s_cbranch_scc1 f2_10
    s_cmp_lg_u32 s3, 0
    s_cbranch_scc1 f2_10
    v_mov_b32 v3, s36
    buffer_store_dword v3, off, s[20:23], 0 sc1
f2_10:
    s_nop 3
    v_and_b32 v16, s39, v16
    v_and_b32 v17, s39, v17
    v_and_b32 v18, s39, v18
    v_and_b32 v19, s39, v19
    v_and_b32 v20, s39, v20
    v_and_b32 v21, s39, v21
    v_and_b32 v22, s39, v22
    v_and_b32 v23, s39, v23
    v_and_b32 v24, s39, v24
    v_and_b32 v25, s39, v25
    v_and_b32 v26, s39, v26
    v_and_b32 v27, s39, v27
    v_and_b32 v28, s39, v28
    v_and_b32 v29, s39, v29
    v_and_b32 v10, s96, v10
    v_and_b32 v11, s96, v11
    v_and_b32 v12, s96, v12
    v_and_b32 v13, s96, v13
    v_pk_mul_f32 v[64:65], v[16:17], v[176:177] op_sel:[0,0] op_sel_hi:[0,1]
    v_pk_mul_f32 v[72:73], v[16:17], v[176:177] op_sel:[1,0] op_sel_hi:[1,1]
    v_pk_mul_f32 v[66:67], v[16:17], v[178:179] op_sel:[0,0] op_sel_hi:[0,1]
    v_pk_mul_f32 v[74:75], v[16:17], v[178:179] op_sel:[1,0] op_sel_hi:[1,1]
    v_pk_mul_f32 v[68:69], v[16:17], v[180:181] op_sel:[0,0] op_sel_hi:[0,1]
    v_pk_mul_f32 v[76:77], v[16:17], v[180:181] op_sel:[1,0] op_sel_hi:[1,1]
    v_pk_mul_f32 v[70:71], v[16:17], v[182:183] op_sel:[0,0] op_sel_hi:[0,1]
    v_pk_mul_f32 v[78:79], v[16:17], v[182:183] op_sel:[1,0] op_sel_hi:[1,1]
    v_pk_fma_f32 v[64:65], v[18:19], v[184:185], v[64:65] op_sel:[0,0,0] op_sel_hi:[0,1,1]
    v_pk_fma_f32 v[72:73], v[18:19], v[184:185], v[72:73] op_sel:[1,0,0] op_sel_hi:[1,1,1]
    v_pk_fma_f32 v[66:67], v[18:19], v[186:187], v[66:67] op_sel:[0,0,0] op_sel_hi:[0,1,1]
    v_pk_fma_f32 v[74:75], v[18:19], v[186:187], v[74:75] op_sel:[1,0,0] op_sel_hi:[1,1,1]
    v_pk_fma_f32 v[68:69], v[18:19], v[188:189], v[68:69] op_sel:[0,0,0] op_sel_hi:[0,1,1]
    v_pk_fma_f32 v[76:77], v[18:19], v[188:189], v[76:77] op_sel:[1,0,0] op_sel_hi:[1,1,1]
    v_pk_fma_f32 v[70:71], v[18:19], v[190:191], v[70:71] op_sel:[0,0,0] op_sel_hi:[0,1,1]
    v_pk_fma_f32 v[78:79], v[18:19], v[190:191], v[78:79] op_sel:[1,0,0] op_sel_hi:[1,1,1]
    v_pk_fma_f32 v[64:65], v[20:21], v[192:193], v[64:65] op_sel:[0,0,0] op_sel_hi:[0,1,1]
    v_pk_fma_f32 v[72:73], v[20:21], v[192:193], v[72:73] op_sel:[1,0,0] op_sel_hi:[1,1,1]
    v_pk_fma_f32 v[66:67], v[20:21], v[194:195], v[66:67] op_sel:[0,0,0] op_sel_hi:[0,1,1]
    v_pk_fma_f32 v[74:75], v[20:21], v[194:195], v[74:75] op_sel:[1,0,0] op_sel_hi:[1,1,1]
    v_pk_fma_f32 v[68:69], v[20:21], v[196:197], v[68:69] op_sel:[0,0,0] op_sel_hi:[0,1,1]
    v_pk_fma_f32 v[76:77], v[20:21], v[196:197], v[76:77] op_sel:[1,0,0] op_sel_hi:[1,1,1]
    v_pk_fma_f32 v[70:71], v[20:21], v[198:199], v[70:71] op_sel:[0,0,0] op_sel_hi:[0,1,1]
    v_pk_fma_f32 v[78:79], v[20:21], v[198:199], v[78:79] op_sel:[1,0,0] op_sel_hi:[1,1,1]
    v_pk_fma_f32 v[64:65], v[22:23], v[200:201], v[64:65] op_sel:[0,0,0] op_sel_hi:[0,1,1]
    v_pk_fma_f32 v[72:73], v[22:23], v[200:201], v[72:73] op_sel:[1,0,0] op_sel_hi:[1,1,1]
    v_pk_fma_f32 v[66:67], v[22:23], v[202:203], v[66:67] op_sel:[0,0,0] op_sel_hi:[0,1,1]
    v_pk_fma_f32 v[74:75], v[22:23], v[202:203], v[74:75] op_sel:[1,0,0] op_sel_hi:[1,1,1]
    v_pk_fma_f32 v[68:69], v[22:23], v[204:205], v[68:69] op_sel:[0,0,0] op_sel_hi:[0,1,1]
    v_pk_fma_f32 v[76:77], v[22:23], v[204:205], v[76:77] op_sel:[1,0,0] op_sel_hi:[1,1,1]
    v_pk_fma_f32 v[70:71], v[22:23], v[206:207], v[70:71] op_sel:[0,0,0] op_sel_hi:[0,1,1]
    v_pk_fma_f32 v[78:79], v[22:23], v[206:207], v[78:79] op_sel:[1,0,0] op_sel_hi:[1,1,1]
    v_pk_fma_f32 v[64:65], v[24:25], v[208:209], v[64:65] op_sel:[0,0,0] op_sel_hi:[0,1,1]
    v_pk_fma_f32 v[72:73], v[24:25], v[208:209], v[72:73] op_sel:[1,0,0] op_sel_hi:[1,1,1]
    v_pk_fma_f32 v[66:67], v[24:25], v[210:211], v[66:67] op_sel:[0,0,0] op_sel_hi:[0,1,1]
    v_pk_fma_f32 v[74:75], v[24:25], v[210:211], v[74:75] op_sel:[1,0,0] op_sel_hi:[1,1,1]
    v_pk_fma_f32 v[68:69], v[24:25], v[212:213], v[68:69] op_sel:[0,0,0] op_sel_hi:[0,1,1]
    v_pk_fma_f32 v[76:77], v[24:25], v[212:213], v[76:77] op_sel:[1,0,0] op_sel_hi:[1,1,1]
    v_pk_fma_f32 v[70:71], v[24:25], v[214:215], v[70:71] op_sel:[0,0,0] op_sel_hi:[0,1,1]
    v_pk_fma_f32 v[78:79], v[24:25], v[214:215], v[78:79] op_sel:[1,0,0] op_sel_hi:[1,1,1]
    v_pk_fma_f32 v[64:65], v[26:27], v[216:217], v[64:65] op_sel:[0,0,0] op_sel_hi:[0,1,1]
    v_pk_fma_f32 v[72:73], v[26:27], v[216:217], v[72:73] op_sel:[1,0,0] op_sel_hi:[1,1,1]
    v_pk_fma_f32 v[66:67], v[26:27], v[218:219], v[66:67] op_sel:[0,0,0] op_sel_hi:[0,1,1]
    v_pk_fma_f32 v[74:75], v[26:27], v[218:219], v[74:75] op_sel:[1,0,0] op_sel_hi:[1,1,1]
    v_pk_fma_f32 v[68:69], v[26:27], v[220:221], v[68:69] op_sel:[0,0,0] op_sel_hi:[0,1,1]
    v_pk_fma_f32 v[76:77], v[26:27], v[220:221], v[76:77] op_sel:[1,0,0] op_sel_hi:[1,1,1]
    v_pk_fma_f32 v[70:71], v[26:27], v[222:223], v[70:71] op_sel:[0,0,0] op_sel_hi:[0,1,1]
    v_pk_fma_f32 v[78:79], v[26:27], v[222:223], v[78:79] op_sel:[1,0,0] op_sel_hi:[1,1,1]
    v_pk_fma_f32 v[64:65], v[28:29], v[224:225], v[64:65] op_sel:[0,0,0] op_sel_hi:[0,1,1]
    v_pk_fma_f32 v[72:73], v[28:29], v[224:225], v[72:73] op_sel:[1,0,0] op_sel_hi:[1,1,1]
    v_pk_fma_f32 v[66:67], v[28:29], v[226:227], v[66:67] op_sel:[0,0,0] op_sel_hi:[0,1,1]
    v_pk_fma_f32 v[74:75], v[28:29], v[226:227], v[74:75] op_sel:[1,0,0] op_sel_hi:[1,1,1]
    v_pk_fma_f32 v[68:69], v[28:29], v[228:229], v[68:69] op_sel:[0,0,0] op_sel_hi:[0,1,1]
    v_pk_fma_f32 v[76:77], v[28:29], v[228:229], v[76:77] op_sel:[1,0,0] op_sel_hi:[1,1,1]
    v_pk_fma_f32 v[70:71], v[28:29], v[230:231], v[70:71] op_sel:[0,0,0] op_sel_hi:[0,1,1]
    v_pk_fma_f32 v[78:79], v[28:29], v[230:231], v[78:79] op_sel:[1,0,0] op_sel_hi:[1,1,1]
    v_permlane32_swap_b32 v64, v72
    v_permlane32_swap_b32 v65, v73
    v_permlane32_swap_b32 v66, v74
    v_permlane32_swap_b32 v67, v75
    v_permlane32_swap_b32 v68, v76
    v_permlane32_swap_b32 v69, v77
    v_permlane32_swap_b32 v70, v78
    v_permlane32_swap_b32 v71, v79
    v_add_f32 v64, v64, v72
    v_add_f32 v65, v65, v73
    v_add_f32 v66, v66, v74
    v_add_f32 v67, v67, v75
    v_add_f32 v68, v68, v76
    v_add_f32 v69, v69, v77
    v_add_f32 v70, v70, v78
    v_add_f32 v71, v71, v79
    v_permlane16_swap_b32 v64, v68
    v_permlane16_swap_b32 v65, v69
    v_permlane16_swap_b32 v66, v70
    v_permlane16_swap_b32 v67, v71
    v_add_f32 v64, v64, v68
    v_add_f32 v65, v65, v69
    v_add_f32 v66, v66, v70
    v_add_f32 v67, v67, v71
    v_add_f32_dpp v64, v64, v64 row_ror:8 row_mask:0xf bank_mask:0x3
    v_add_f32_dpp v65, v65, v65 row_ror:8 row_mask:0xf bank_mask:0x3
    v_add_f32_dpp v64, v66, v66 row_ror:8 row_mask:0xf bank_mask:0xc
    v_add_f32_dpp v65, v67, v67 row_ror:8 row_mask:0xf bank_mask:0xc
    s_nop 0
    v_add_f32_dpp v64, v64, v64 row_shl:4 row_mask:0xf bank_mask:0x5
    v_add_f32_dpp v64, v65, v65 row_shr:4 row_mask:0xf bank_mask:0xa
    s_nop 1
    v_add_f32_dpp v64, v64, v64 quad_perm:[2,3,0,1] row_mask:0xf bank_mask:0xf
    v_lshrrev_b32 v3, 5, v0
    v_lshlrev_b32 v3, 4, v3
    v_and_b32 v2, 1, v0
    v_lshl_add_u32 v3, v2, 3, v3
    v_bfe_u32 v2, v0, 2, 3
    v_add_u32 v3, v3, v2
    v_lshlrev_b32 v3, 2, v3
    s_lshl_b32 s40, s3, 8
    v_add_u32 v3, s40, v3
    ds_write_b32 v3, v64 offset:29184
    s_waitcnt lgkmcnt(0)
    s_barrier
    s_cmp_lg_u32 s3, 0
    s_cbranch_scc1 END
    v_lshlrev_b32 v3, 2, v0
    ds_read_b32 v80, v3 offset:29184
    ds_read_b32 v81, v3 offset:29440
    ds_read_b32 v82, v3 offset:29696
    ds_read_b32 v83, v3 offset:29952
    ds_read_b32 v84, v3 offset:30208
    ds_read_b32 v85, v3 offset:30464
    ds_read_b32 v86, v3 offset:30720
    ds_read_b32 v87, v3 offset:30976
    s_waitcnt lgkmcnt(0)
    v_add_f32 v80, v80, v84
    v_add_f32 v81, v81, v85
    v_add_f32 v82, v82, v86
    v_add_f32 v83, v83, v87
    v_add_f32 v80, v80, v82
    v_add_f32 v81, v81, v83
    v_add_f32 v80, v80, v81
    v_add_f32 v10, v10, v11
    v_add_f32 v12, v12, v13
    v_add_f32 v10, v10, v12
    v_cvt_pk_bf16_f32 v92, v10, v80
    v_lshlrev_b32 v10, 16, v92
    v_and_b32 v80, s39, v92
    v_lshlrev_b32 v14, 16, v14
    v_add_f32 v10, v10, v14
    v_cvt_pk_bf16_f32 v10, v10, v10
    v_and_b32 v10, s39, v10
    v_add_f32 v10, v10, v80
    v_cvt_pk_bf16_f32 v10, v10, v10
    s_mov_b32 exec_hi, 0
    buffer_store_short v10, v8, s[28:31], 0 offen
    s_waitcnt vmcnt(0)
END:
    s_nop 3
    s_waitcnt vmcnt(0)
s_endpgm
.section .rodata,"a"
.p2align 6
.amdhsa_kernel sequential_preLN__gqa_block_cached__dense_activation_relu__decode_kernel
  .amdhsa_next_free_vgpr 256
  .amdhsa_next_free_sgpr 102
  .amdhsa_accum_offset 256
  .amdhsa_group_segment_fixed_size 0
  .amdhsa_kernarg_size 88
  .amdhsa_user_sgpr_count 2
  .amdhsa_user_sgpr_kernarg_segment_ptr 1
  .amdhsa_system_sgpr_workgroup_id_x 1
.end_amdhsa_kernel
```
